```python
import torch

def _softmax(x, axis=-1):
    return torch.softmax(x, dim=axis)
def _gelu(x):
    return torch.nn.functional.gelu(x, approximate="tanh")
def _silu(x):
    return torch.nn.functional.silu(x)
def _sigmoid(x):
    return torch.sigmoid(x)
def _layernorm(x, axis=-1, eps=1e-5):
    m = x.mean(dim=axis, keepdim=True)
    v = x.var(dim=axis, keepdim=True, unbiased=False)
    return (x - m) / torch.sqrt(v + eps)
def _scatter_add(tgt, idx, src, axis=0):
    return tgt.clone().index_add_(axis, idx, src)
def _segment_sum(src, seg, n):
    out = torch.zeros((n,) + src.shape[1:], dtype=src.dtype)
    return out.index_add_(0, seg, src)
def _pad(x, pw):
    flat = tuple(v for pair in reversed(pw) for v in pair)
    return torch.nn.functional.pad(x, flat)

kernel_name = 'gated_mix__softmax_full_mha__dense_activation_relu__prompt'

def setup_inputs():

    _w = (lambda a: (lambda t: t.to(torch.bfloat16) if t.is_floating_point() else t)(torch.as_tensor(a)))
    def _A_setup():
        B, S, D = 1, 2048, 512
        return {
            "x": _w((lambda *s: torch.randn(*s, dtype=torch.bfloat16) * 0.05)(B, S, D)),
            "wqkv": _w((lambda *s: torch.randn(*s, dtype=torch.bfloat16) * 0.8)(D, 3 * D)),
            "wo": _w((lambda *s: torch.randn(*s, dtype=torch.bfloat16) * 0.1)(D, D)),
        }
    _A_in = _A_setup()

    def _B_setup():
        B, S, D, Dff = 1, 2048, 512, 1376
        return {
            "x": _w((lambda *s: torch.randn(*s, dtype=torch.bfloat16) * 0.05)(B, S, D)),
            "w1": _w((lambda *s: torch.randn(*s, dtype=torch.bfloat16) * 0.05)(D, Dff)),
            "w2": _w((lambda *s: torch.randn(*s, dtype=torch.bfloat16) * 0.05)(Dff, D)),
        }
    _B_in = _B_setup()

    return {
        "A_x": _A_in["x"],
        "A_wqkv": _A_in["wqkv"],
        "A_wo": _A_in["wo"],
        "B_x": _B_in["x"],
        "B_w1": _B_in["w1"],
        "B_w2": _B_in["w2"],
        "gate_w": _w((lambda *s: torch.randn(*s, dtype=torch.bfloat16) * 0.05)(512) * 16.0),
    }

def reference(A_x, A_wqkv, A_wo, B_x, B_w1, B_w2, gate_w):
    def _A_ref(x, wqkv, wo):
        B, S, D = x.shape
        H = 32; Dh = D // H
        qkv = (lambda x, *d: x.permute(*d))((x @ wqkv).reshape(B, S, 3, H, Dh), 2, 0, 3, 1, 4)
        q, k, v = qkv[0], qkv[1], qkv[2]
        scale = Dh ** -0.5
        scores = torch.einsum("bhqd,bhkd->bhqk", q, k) * scale
        p = _softmax(scores, axis=-1)
        o = torch.einsum("bhqk,bhkd->bhqd", p, v)
        return (lambda x, *d: x.permute(*d))(o, 0, 2, 1, 3).reshape(B, S, D) @ wo

    def _B_ref(x, w1, w2):
        h = torch.einsum("bsd,df->bsf", x, w1)
        zero = torch.zeros_like(h)
        h = torch.maximum(h, zero)
        return torch.einsum("bsf,fd->bsd", h, w2)

    x = A_x
    g = _sigmoid((x * gate_w).sum(-1, keepdims=True))
    a = _A_ref(x, A_wqkv, A_wo)
    b = _B_ref(x, B_w1, B_w2)
    return g * a + (1 - g) * b
```

```asm
; @launch kernel=qkv_kernel grid=(256,1,1) block=(256,1,1) lds=94208
; @launch kernel=attn_kernel grid=(256,1,1) block=(512,1,1) lds=134144
; @launch kernel=final_kernel grid=(256,1,1) block=(256,1,1) lds=131072
.amdgcn_target "amdgcn-amd-amdhsa--gfx950"
.text
.globl qkv_kernel
.globl attn_kernel
.globl final_kernel
.p2align 8
.type qkv_kernel,@function
qkv_kernel:
    s_cmp_ge_u32 s2, 256
    s_cbranch_scc1 K1_END
    s_load_dwordx2 s[26:27], s[0:1], 0
    s_load_dwordx2 s[28:29], s[0:1], 8
    s_load_dwordx2 s[30:31], s[0:1], 32
    s_load_dwordx2 s[32:33], s[0:1], 72
    s_and_b32 s3, s2, 15
    s_lshr_b32 s4, s2, 4
    v_lshrrev_b32 v14, 6, v0
    v_and_b32 v1, 63, v0
    v_readfirstlane_b32 s5, v14
    s_nop 3
    s_and_b32 s6, s5, 1
    s_lshr_b32 s7, s5, 1
    s_waitcnt lgkmcnt(0)
    s_mov_b32 s8, s26
    s_and_b32 s9, s27, 0xffff
    s_mov_b32 s10, 2097152
    s_mov_b32 s11, 0x00020000
    s_mov_b32 s16, s32
    s_and_b32 s17, s33, 0xffff
    s_mov_b32 s18, 16777216
    s_mov_b32 s19, 0x00020000
    s_cmp_lt_u32 s4, 8
    s_cbranch_scc0 K1_W1
    s_mov_b32 s12, s28
    s_and_b32 s13, s29, 0xffff
    s_mov_b32 s14, 1572864
    s_mov_b32 s15, 0x00020000
    s_movk_i32 s20, 3072
    s_mul_i32 s22, s4, 384
    s_branch K1_WDONE
K1_W1:
    s_mov_b32 s12, s30
    s_and_b32 s13, s31, 0xffff
    s_mov_b32 s14, 1409024
    s_mov_b32 s15, 0x00020000
    s_movk_i32 s20, 2752
    s_sub_u32 s25, s4, 8
    s_mul_i32 s22, s25, 384
K1_WDONE:
    s_lshl_b32 s23, s20, 6
    s_mov_b32 s21, 0
    v_lshrrev_b32 v14, 3, v0
    v_and_b32 v15, 7, v0
    s_lshl_b32 s25, s3, 7
    v_add_u32 v2, s25, v14
    v_lshlrev_b32 v2, 10, v2
    v_lshl_add_u32 v2, v15, 4, v2
    v_add_u32 v3, 0x8000, v2
    v_add_u32 v4, 0x10000, v2
    v_add_u32 v5, 0x18000, v2
    v_mul_lo_u32 v6, v14, s20
    v_lshl_add_u32 v6, v15, 4, v6
    s_lshl_b32 s25, s20, 5
    v_add_u32 v7, s25, v6
    v_mul_u32_u24 v8, 144, v14
    v_lshl_add_u32 v8, v15, 4, v8
    v_mul_u32_u24 v9, 448, v14
    v_lshl_add_u32 v9, v15, 4, v9
    v_add_u32 v9, 18432, v9
    v_and_b32 v14, 31, v1
    s_lshl_b32 s25, s6, 6
    v_add_u32 v14, s25, v14
    v_mul_u32_u24 v10, 144, v14
    v_lshrrev_b32 v15, 5, v1
    v_lshl_add_u32 v10, v15, 4, v10
    v_add_u32 v11, 47104, v10
    v_lshrrev_b32 v14, 5, v1
    v_lshlrev_b32 v14, 3, v14
    v_bfe_u32 v15, v1, 2, 2
    v_add_u32 v14, v14, v15
    v_mul_u32_u24 v12, 448, v14
    v_bfe_u32 v14, v1, 4, 1
    v_lshlrev_b32 v14, 5, v14
    v_and_b32 v15, 3, v1
    v_lshl_add_u32 v14, v15, 3, v14
    v_add_u32 v12, v12, v14
    s_mul_i32 s25, s7, 192
    s_add_u32 s25, s25, 18432
    v_add_u32 v12, s25, v12
    v_add_u32 v13, 47104, v12
    v_mov_b32 v96, 0
    v_mov_b32 v97, 0
    v_mov_b32 v98, 0
    v_mov_b32 v99, 0
    v_mov_b32 v100, 0
    v_mov_b32 v101, 0
    v_mov_b32 v102, 0
    v_mov_b32 v103, 0
    v_mov_b32 v104, 0
    v_mov_b32 v105, 0
    v_mov_b32 v106, 0
    v_mov_b32 v107, 0
    v_mov_b32 v108, 0
    v_mov_b32 v109, 0
    v_mov_b32 v110, 0
    v_mov_b32 v111, 0
    v_mov_b32 v112, 0
    v_mov_b32 v113, 0
    v_mov_b32 v114, 0
    v_mov_b32 v115, 0
    v_mov_b32 v116, 0
    v_mov_b32 v117, 0
    v_mov_b32 v118, 0
    v_mov_b32 v119, 0
    v_mov_b32 v120, 0
    v_mov_b32 v121, 0
    v_mov_b32 v122, 0
    v_mov_b32 v123, 0
    v_mov_b32 v124, 0
    v_mov_b32 v125, 0
    v_mov_b32 v126, 0
    v_mov_b32 v127, 0
    v_mov_b32 v128, 0
    v_mov_b32 v129, 0
    v_mov_b32 v130, 0
    v_mov_b32 v131, 0
    v_mov_b32 v132, 0
    v_mov_b32 v133, 0
    v_mov_b32 v134, 0
    v_mov_b32 v135, 0
    v_mov_b32 v136, 0
    v_mov_b32 v137, 0
    v_mov_b32 v138, 0
    v_mov_b32 v139, 0
    v_mov_b32 v140, 0
    v_mov_b32 v141, 0
    v_mov_b32 v142, 0
    v_mov_b32 v143, 0
    v_mov_b32 v144, 0
    v_mov_b32 v145, 0
    v_mov_b32 v146, 0
    v_mov_b32 v147, 0
    v_mov_b32 v148, 0
    v_mov_b32 v149, 0
    v_mov_b32 v150, 0
    v_mov_b32 v151, 0
    v_mov_b32 v152, 0
    v_mov_b32 v153, 0
    v_mov_b32 v154, 0
    v_mov_b32 v155, 0
    v_mov_b32 v156, 0
    v_mov_b32 v157, 0
    v_mov_b32 v158, 0
    v_mov_b32 v159, 0
    v_mov_b32 v160, 0
    v_mov_b32 v161, 0
    v_mov_b32 v162, 0
    v_mov_b32 v163, 0
    v_mov_b32 v164, 0
    v_mov_b32 v165, 0
    v_mov_b32 v166, 0
    v_mov_b32 v167, 0
    v_mov_b32 v168, 0
    v_mov_b32 v169, 0
    v_mov_b32 v170, 0
    v_mov_b32 v171, 0
    v_mov_b32 v172, 0
    v_mov_b32 v173, 0
    v_mov_b32 v174, 0
    v_mov_b32 v175, 0
    v_mov_b32 v176, 0
    v_mov_b32 v177, 0
    v_mov_b32 v178, 0
    v_mov_b32 v179, 0
    v_mov_b32 v180, 0
    v_mov_b32 v181, 0
    v_mov_b32 v182, 0
    v_mov_b32 v183, 0
    v_mov_b32 v184, 0
    v_mov_b32 v185, 0
    v_mov_b32 v186, 0
    v_mov_b32 v187, 0
    v_mov_b32 v188, 0
    v_mov_b32 v189, 0
    v_mov_b32 v190, 0
    v_mov_b32 v191, 0
    buffer_load_dwordx4 v[16:19], v2, s[8:11], s21 offen
    buffer_load_dwordx4 v[20:23], v3, s[8:11], s21 offen
    buffer_load_dwordx4 v[24:27], v4, s[8:11], s21 offen
    buffer_load_dwordx4 v[28:31], v5, s[8:11], s21 offen
    buffer_load_dwordx4 v[32:35], v6, s[12:15], s22 offen offset:0
    buffer_load_dwordx4 v[36:39], v6, s[12:15], s22 offen offset:128
    buffer_load_dwordx4 v[40:43], v6, s[12:15], s22 offen offset:256
    buffer_load_dwordx4 v[44:47], v7, s[12:15], s22 offen offset:0
    buffer_load_dwordx4 v[48:51], v7, s[12:15], s22 offen offset:128
    buffer_load_dwordx4 v[52:55], v7, s[12:15], s22 offen offset:256
    s_waitcnt vmcnt(0)
    ds_write_b128 v8, v[16:19] offset:0
    ds_write_b128 v8, v[20:23] offset:4608
    ds_write_b128 v8, v[24:27] offset:9216
    ds_write_b128 v8, v[28:31] offset:13824
    ds_write_b128 v9, v[32:35] offset:0
    ds_write_b128 v9, v[36:39] offset:128
    ds_write_b128 v9, v[40:43] offset:256
    ds_write_b128 v9, v[44:47] offset:14336
    ds_write_b128 v9, v[48:51] offset:14464
    ds_write_b128 v9, v[52:55] offset:14592
    s_waitcnt lgkmcnt(0)
    s_barrier
    s_and_b32 s25, s4, 7
    s_mul_i32 s25, s25, 6
    s_mul_i32 s34, s7, 3
    s_add_u32 s25, s25, s34
    s_cmp_ge_u32 s4, 8
    s_cbranch_scc1 K1_TTT
    s_cmp_ge_u32 s25, 33
    s_cbranch_scc1 K1_NNN
    s_cmp_eq_u32 s25, 30
    s_cbranch_scc1 K1_TTN
K1_TTT:
    s_mov_b32 s24, 0
K1_LTTT:
    s_add_u32 s21, s21, 128
    s_add_u32 s22, s22, s23
    buffer_load_dwordx4 v[16:19], v2, s[8:11], s21 offen
    buffer_load_dwordx4 v[20:23], v3, s[8:11], s21 offen
    buffer_load_dwordx4 v[24:27], v4, s[8:11], s21 offen
    buffer_load_dwordx4 v[28:31], v5, s[8:11], s21 offen
    buffer_load_dwordx4 v[32:35], v6, s[12:15], s22 offen offset:0
    buffer_load_dwordx4 v[36:39], v6, s[12:15], s22 offen offset:128
    buffer_load_dwordx4 v[40:43], v6, s[12:15], s22 offen offset:256
    buffer_load_dwordx4 v[44:47], v7, s[12:15], s22 offen offset:0
    buffer_load_dwordx4 v[48:51], v7, s[12:15], s22 offen offset:128
    buffer_load_dwordx4 v[52:55], v7, s[12:15], s22 offen offset:256
    ds_read_b128 v[56:59], v10 offset:0
    ds_read_b128 v[60:63], v10 offset:4608
    ds_read_b64_tr_b16 v[64:65], v12 offset:0
    ds_read_b64_tr_b16 v[66:67], v12 offset:1792
    ds_read_b64_tr_b16 v[68:69], v12 offset:64
    ds_read_b64_tr_b16 v[70:71], v12 offset:1856
    ds_read_b64_tr_b16 v[72:73], v12 offset:128
    ds_read_b64_tr_b16 v[74:75], v12 offset:1920
    ds_read_b128 v[76:79], v10 offset:32
    ds_read_b128 v[80:83], v10 offset:4640
    ds_read_b64_tr_b16 v[84:85], v12 offset:7168
    ds_read_b64_tr_b16 v[86:87], v12 offset:8960
    ds_read_b64_tr_b16 v[88:89], v12 offset:7232
    ds_read_b64_tr_b16 v[90:91], v12 offset:9024
    ds_read_b64_tr_b16 v[92:93], v12 offset:7296
    ds_read_b64_tr_b16 v[94:95], v12 offset:9088
    s_waitcnt lgkmcnt(8)
    v_mfma_f32_32x32x16_bf16 v[96:111], v[64:67], v[56:59], v[96:111]
    v_mfma_f32_32x32x16_bf16 v[112:127], v[68:71], v[56:59], v[112:127]
    v_mfma_f32_32x32x16_bf16 v[128:143], v[72:75], v[56:59], v[128:143]
    v_mfma_f32_32x32x16_bf16 v[144:159], v[64:67], v[60:63], v[144:159]
    v_mfma_f32_32x32x16_bf16 v[160:175], v[68:71], v[60:63], v[160:175]
    v_mfma_f32_32x32x16_bf16 v[176:191], v[72:75], v[60:63], v[176:191]
    ds_read_b128 v[56:59], v10 offset:64
    ds_read_b128 v[60:63], v10 offset:4672
    ds_read_b64_tr_b16 v[64:65], v12 offset:14336
    ds_read_b64_tr_b16 v[66:67], v12 offset:16128
    ds_read_b64_tr_b16 v[68:69], v12 offset:14400
    ds_read_b64_tr_b16 v[70:71], v12 offset:16192
    ds_read_b64_tr_b16 v[72:73], v12 offset:14464
    ds_read_b64_tr_b16 v[74:75], v12 offset:16256
    s_waitcnt lgkmcnt(8)
    v_mfma_f32_32x32x16_bf16 v[96:111], v[84:87], v[76:79], v[96:111]
    v_mfma_f32_32x32x16_bf16 v[112:127], v[88:91], v[76:79], v[112:127]
    v_mfma_f32_32x32x16_bf16 v[128:143], v[92:95], v[76:79], v[128:143]
    v_mfma_f32_32x32x16_bf16 v[144:159], v[84:87], v[80:83], v[144:159]
    v_mfma_f32_32x32x16_bf16 v[160:175], v[88:91], v[80:83], v[160:175]
    v_mfma_f32_32x32x16_bf16 v[176:191], v[92:95], v[80:83], v[176:191]
    ds_read_b128 v[76:79], v10 offset:96
    ds_read_b128 v[80:83], v10 offset:4704
    ds_read_b64_tr_b16 v[84:85], v12 offset:21504
    ds_read_b64_tr_b16 v[86:87], v12 offset:23296
    ds_read_b64_tr_b16 v[88:89], v12 offset:21568
    ds_read_b64_tr_b16 v[90:91], v12 offset:23360
    ds_read_b64_tr_b16 v[92:93], v12 offset:21632
    ds_read_b64_tr_b16 v[94:95], v12 offset:23424
    s_waitcnt lgkmcnt(8)
    v_mfma_f32_32x32x16_bf16 v[96:111], v[64:67], v[56:59], v[96:111]
    v_mfma_f32_32x32x16_bf16 v[112:127], v[68:71], v[56:59], v[112:127]
    v_mfma_f32_32x32x16_bf16 v[128:143], v[72:75], v[56:59], v[128:143]
    v_mfma_f32_32x32x16_bf16 v[144:159], v[64:67], v[60:63], v[144:159]
    v_mfma_f32_32x32x16_bf16 v[160:175], v[68:71], v[60:63], v[160:175]
    v_mfma_f32_32x32x16_bf16 v[176:191], v[72:75], v[60:63], v[176:191]
    s_waitcnt lgkmcnt(0)
    v_mfma_f32_32x32x16_bf16 v[96:111], v[84:87], v[76:79], v[96:111]
    v_mfma_f32_32x32x16_bf16 v[112:127], v[88:91], v[76:79], v[112:127]
    v_mfma_f32_32x32x16_bf16 v[128:143], v[92:95], v[76:79], v[128:143]
    v_mfma_f32_32x32x16_bf16 v[144:159], v[84:87], v[80:83], v[144:159]
    v_mfma_f32_32x32x16_bf16 v[160:175], v[88:91], v[80:83], v[160:175]
    v_mfma_f32_32x32x16_bf16 v[176:191], v[92:95], v[80:83], v[176:191]
    s_waitcnt vmcnt(0)
    ds_write_b128 v8, v[16:19] offset:47104
    ds_write_b128 v8, v[20:23] offset:51712
    ds_write_b128 v8, v[24:27] offset:56320
    ds_write_b128 v8, v[28:31] offset:60928
    ds_write_b128 v9, v[32:35] offset:47104
    ds_write_b128 v9, v[36:39] offset:47232
    ds_write_b128 v9, v[40:43] offset:47360
    ds_write_b128 v9, v[44:47] offset:61440
    ds_write_b128 v9, v[48:51] offset:61568
    ds_write_b128 v9, v[52:55] offset:61696
    s_waitcnt lgkmcnt(0)
    s_barrier
    s_add_u32 s21, s21, 128
    s_add_u32 s22, s22, s23
    buffer_load_dwordx4 v[16:19], v2, s[8:11], s21 offen
    buffer_load_dwordx4 v[20:23], v3, s[8:11], s21 offen
    buffer_load_dwordx4 v[24:27], v4, s[8:11], s21 offen
    buffer_load_dwordx4 v[28:31], v5, s[8:11], s21 offen
    buffer_load_dwordx4 v[32:35], v6, s[12:15], s22 offen offset:0
    buffer_load_dwordx4 v[36:39], v6, s[12:15], s22 offen offset:128
    buffer_load_dwordx4 v[40:43], v6, s[12:15], s22 offen offset:256
    buffer_load_dwordx4 v[44:47], v7, s[12:15], s22 offen offset:0
    buffer_load_dwordx4 v[48:51], v7, s[12:15], s22 offen offset:128
    buffer_load_dwordx4 v[52:55], v7, s[12:15], s22 offen offset:256
    ds_read_b128 v[56:59], v11 offset:0
    ds_read_b128 v[60:63], v11 offset:4608
    ds_read_b64_tr_b16 v[64:65], v13 offset:0
    ds_read_b64_tr_b16 v[66:67], v13 offset:1792
    ds_read_b64_tr_b16 v[68:69], v13 offset:64
    ds_read_b64_tr_b16 v[70:71], v13 offset:1856
    ds_read_b64_tr_b16 v[72:73], v13 offset:128
    ds_read_b64_tr_b16 v[74:75], v13 offset:1920
    ds_read_b128 v[76:79], v11 offset:32
    ds_read_b128 v[80:83], v11 offset:4640
    ds_read_b64_tr_b16 v[84:85], v13 offset:7168
    ds_read_b64_tr_b16 v[86:87], v13 offset:8960
    ds_read_b64_tr_b16 v[88:89], v13 offset:7232
    ds_read_b64_tr_b16 v[90:91], v13 offset:9024
    ds_read_b64_tr_b16 v[92:93], v13 offset:7296
    ds_read_b64_tr_b16 v[94:95], v13 offset:9088
    s_waitcnt lgkmcnt(8)
    v_mfma_f32_32x32x16_bf16 v[96:111], v[64:67], v[56:59], v[96:111]
    v_mfma_f32_32x32x16_bf16 v[112:127], v[68:71], v[56:59], v[112:127]
    v_mfma_f32_32x32x16_bf16 v[128:143], v[72:75], v[56:59], v[128:143]
    v_mfma_f32_32x32x16_bf16 v[144:159], v[64:67], v[60:63], v[144:159]
    v_mfma_f32_32x32x16_bf16 v[160:175], v[68:71], v[60:63], v[160:175]
    v_mfma_f32_32x32x16_bf16 v[176:191], v[72:75], v[60:63], v[176:191]
    ds_read_b128 v[56:59], v11 offset:64
    ds_read_b128 v[60:63], v11 offset:4672
    ds_read_b64_tr_b16 v[64:65], v13 offset:14336
    ds_read_b64_tr_b16 v[66:67], v13 offset:16128
    ds_read_b64_tr_b16 v[68:69], v13 offset:14400
    ds_read_b64_tr_b16 v[70:71], v13 offset:16192
    ds_read_b64_tr_b16 v[72:73], v13 offset:14464
    ds_read_b64_tr_b16 v[74:75], v13 offset:16256
    s_waitcnt lgkmcnt(8)
    v_mfma_f32_32x32x16_bf16 v[96:111], v[84:87], v[76:79], v[96:111]
    v_mfma_f32_32x32x16_bf16 v[112:127], v[88:91], v[76:79], v[112:127]
    v_mfma_f32_32x32x16_bf16 v[128:143], v[92:95], v[76:79], v[128:143]
    v_mfma_f32_32x32x16_bf16 v[144:159], v[84:87], v[80:83], v[144:159]
    v_mfma_f32_32x32x16_bf16 v[160:175], v[88:91], v[80:83], v[160:175]
    v_mfma_f32_32x32x16_bf16 v[176:191], v[92:95], v[80:83], v[176:191]
    ds_read_b128 v[76:79], v11 offset:96
    ds_read_b128 v[80:83], v11 offset:4704
    ds_read_b64_tr_b16 v[84:85], v13 offset:21504
    ds_read_b64_tr_b16 v[86:87], v13 offset:23296
    ds_read_b64_tr_b16 v[88:89], v13 offset:21568
    ds_read_b64_tr_b16 v[90:91], v13 offset:23360
    ds_read_b64_tr_b16 v[92:93], v13 offset:21632
    ds_read_b64_tr_b16 v[94:95], v13 offset:23424
    s_waitcnt lgkmcnt(8)
    v_mfma_f32_32x32x16_bf16 v[96:111], v[64:67], v[56:59], v[96:111]
    v_mfma_f32_32x32x16_bf16 v[112:127], v[68:71], v[56:59], v[112:127]
    v_mfma_f32_32x32x16_bf16 v[128:143], v[72:75], v[56:59], v[128:143]
    v_mfma_f32_32x32x16_bf16 v[144:159], v[64:67], v[60:63], v[144:159]
    v_mfma_f32_32x32x16_bf16 v[160:175], v[68:71], v[60:63], v[160:175]
    v_mfma_f32_32x32x16_bf16 v[176:191], v[72:75], v[60:63], v[176:191]
    s_waitcnt lgkmcnt(0)
    v_mfma_f32_32x32x16_bf16 v[96:111], v[84:87], v[76:79], v[96:111]
    v_mfma_f32_32x32x16_bf16 v[112:127], v[88:91], v[76:79], v[112:127]
    v_mfma_f32_32x32x16_bf16 v[128:143], v[92:95], v[76:79], v[128:143]
    v_mfma_f32_32x32x16_bf16 v[144:159], v[84:87], v[80:83], v[144:159]
    v_mfma_f32_32x32x16_bf16 v[160:175], v[88:91], v[80:83], v[160:175]
    v_mfma_f32_32x32x16_bf16 v[176:191], v[92:95], v[80:83], v[176:191]
    s_waitcnt vmcnt(0)
    ds_write_b128 v8, v[16:19] offset:0
    ds_write_b128 v8, v[20:23] offset:4608
    ds_write_b128 v8, v[24:27] offset:9216
    ds_write_b128 v8, v[28:31] offset:13824
    ds_write_b128 v9, v[32:35] offset:0
    ds_write_b128 v9, v[36:39] offset:128
    ds_write_b128 v9, v[40:43] offset:256
    ds_write_b128 v9, v[44:47] offset:14336
    ds_write_b128 v9, v[48:51] offset:14464
    ds_write_b128 v9, v[52:55] offset:14592
    s_waitcnt lgkmcnt(0)
    s_barrier
    s_add_u32 s24, s24, 1
    s_cmp_lt_u32 s24, 4
    s_cbranch_scc1 K1_LTTT
    s_nop 7
    s_nop 7
    v_lshlrev_b32 v14, 4, v1
    s_lshl_b32 s35, s3, 2
    s_lshl_b32 s36, s6, 1
    s_add_u32 s35, s35, s36
    s_add_u32 s35, s35, 0
    s_add_u32 s36, s25, 0
    s_cmp_ge_u32 s4, 8
    s_cbranch_scc1 K1_ETTT_00_H
    s_and_b32 s37, s36, 15
    s_lshl_b32 s37, s37, 17
    s_lshl_b32 s38, s35, 10
    s_add_u32 s37, s37, s38
    s_mov_b32 s39, 1052289595
    s_mov_b32 s40, 0xff800000
    s_mov_b32 s41, 65536
    s_cmp_lt_u32 s36, 16
    s_cbranch_scc1 K1_ETTT_00_GO
    s_add_u32 s37, s37, 2097152
    s_mov_b32 s39, 1.0
    s_branch K1_ETTT_00_GO
K1_ETTT_00_H:
    s_cmp_ge_u32 s36, 43
    s_cbranch_scc1 K1_ETTT_00_SKIP
    s_mul_i32 s37, s35, 86
    s_lshl_b32 s38, s36, 1
    s_add_u32 s37, s37, s38
    s_lshl_b32 s37, s37, 10
    s_add_u32 s37, s37, 6291456
    s_mov_b32 s39, 1.0
    s_mov_b32 s40, 0
    s_movk_i32 s41, 1024
K1_ETTT_00_GO:
    v_mul_f32 v192, s39, v96
    v_max_f32 v192, s40, v192
    v_mul_f32 v193, s39, v97
    v_max_f32 v193, s40, v193
    v_mul_f32 v194, s39, v98
    v_max_f32 v194, s40, v194
    v_mul_f32 v195, s39, v99
    v_max_f32 v195, s40, v195
    v_mul_f32 v196, s39, v100
    v_max_f32 v196, s40, v196
    v_mul_f32 v197, s39, v101
    v_max_f32 v197, s40, v197
    v_mul_f32 v198, s39, v102
    v_max_f32 v198, s40, v198
    v_mul_f32 v199, s39, v103
    v_max_f32 v199, s40, v199
    v_cvt_pk_bf16_f32 v200, v192, v193
    v_cvt_pk_bf16_f32 v201, v194, v195
    v_cvt_pk_bf16_f32 v202, v196, v197
    v_cvt_pk_bf16_f32 v203, v198, v199
    buffer_store_dwordx4 v[200:203], v14, s[16:19], s37 offen
    s_nop 1
    v_mul_f32 v192, s39, v104
    v_max_f32 v192, s40, v192
    v_mul_f32 v193, s39, v105
    v_max_f32 v193, s40, v193
    v_mul_f32 v194, s39, v106
    v_max_f32 v194, s40, v194
    v_mul_f32 v195, s39, v107
    v_max_f32 v195, s40, v195
    v_mul_f32 v196, s39, v108
    v_max_f32 v196, s40, v196
    v_mul_f32 v197, s39, v109
    v_max_f32 v197, s40, v197
    v_mul_f32 v198, s39, v110
    v_max_f32 v198, s40, v198
    v_mul_f32 v199, s39, v111
    v_max_f32 v199, s40, v199
    v_cvt_pk_bf16_f32 v200, v192, v193
    v_cvt_pk_bf16_f32 v201, v194, v195
    v_cvt_pk_bf16_f32 v202, v196, v197
    v_cvt_pk_bf16_f32 v203, v198, v199
    s_add_u32 s37, s37, s41
    buffer_store_dwordx4 v[200:203], v14, s[16:19], s37 offen
    s_nop 1
K1_ETTT_00_SKIP:
    s_lshl_b32 s35, s3, 2
    s_lshl_b32 s36, s6, 1
    s_add_u32 s35, s35, s36
    s_add_u32 s35, s35, 0
    s_add_u32 s36, s25, 1
    s_cmp_ge_u32 s4, 8
    s_cbranch_scc1 K1_ETTT_01_H
    s_and_b32 s37, s36, 15
    s_lshl_b32 s37, s37, 17
    s_lshl_b32 s38, s35, 10
    s_add_u32 s37, s37, s38
    s_mov_b32 s39, 1052289595
    s_mov_b32 s40, 0xff800000
    s_mov_b32 s41, 65536
    s_cmp_lt_u32 s36, 16
    s_cbranch_scc1 K1_ETTT_01_GO
    s_add_u32 s37, s37, 2097152
    s_mov_b32 s39, 1.0
    s_branch K1_ETTT_01_GO
K1_ETTT_01_H:
    s_cmp_ge_u32 s36, 43
    s_cbranch_scc1 K1_ETTT_01_SKIP
    s_mul_i32 s37, s35, 86
    s_lshl_b32 s38, s36, 1
    s_add_u32 s37, s37, s38
    s_lshl_b32 s37, s37, 10
    s_add_u32 s37, s37, 6291456
    s_mov_b32 s39, 1.0
    s_mov_b32 s40, 0
    s_movk_i32 s41, 1024
K1_ETTT_01_GO:
    v_mul_f32 v192, s39, v112
    v_max_f32 v192, s40, v192
    v_mul_f32 v193, s39, v113
    v_max_f32 v193, s40, v193
    v_mul_f32 v194, s39, v114
    v_max_f32 v194, s40, v194
    v_mul_f32 v195, s39, v115
    v_max_f32 v195, s40, v195
    v_mul_f32 v196, s39, v116
    v_max_f32 v196, s40, v196
    v_mul_f32 v197, s39, v117
    v_max_f32 v197, s40, v197
    v_mul_f32 v198, s39, v118
    v_max_f32 v198, s40, v198
    v_mul_f32 v199, s39, v119
    v_max_f32 v199, s40, v199
    v_cvt_pk_bf16_f32 v200, v192, v193
    v_cvt_pk_bf16_f32 v201, v194, v195
    v_cvt_pk_bf16_f32 v202, v196, v197
    v_cvt_pk_bf16_f32 v203, v198, v199
    buffer_store_dwordx4 v[200:203], v14, s[16:19], s37 offen
    s_nop 1
    v_mul_f32 v192, s39, v120
    v_max_f32 v192, s40, v192
    v_mul_f32 v193, s39, v121
    v_max_f32 v193, s40, v193
    v_mul_f32 v194, s39, v122
    v_max_f32 v194, s40, v194
    v_mul_f32 v195, s39, v123
    v_max_f32 v195, s40, v195
    v_mul_f32 v196, s39, v124
    v_max_f32 v196, s40, v196
    v_mul_f32 v197, s39, v125
    v_max_f32 v197, s40, v197
    v_mul_f32 v198, s39, v126
    v_max_f32 v198, s40, v198
    v_mul_f32 v199, s39, v127
    v_max_f32 v199, s40, v199
    v_cvt_pk_bf16_f32 v200, v192, v193
    v_cvt_pk_bf16_f32 v201, v194, v195
    v_cvt_pk_bf16_f32 v202, v196, v197
    v_cvt_pk_bf16_f32 v203, v198, v199
    s_add_u32 s37, s37, s41
    buffer_store_dwordx4 v[200:203], v14, s[16:19], s37 offen
    s_nop 1
K1_ETTT_01_SKIP:
    s_lshl_b32 s35, s3, 2
    s_lshl_b32 s36, s6, 1
    s_add_u32 s35, s35, s36
    s_add_u32 s35, s35, 0
    s_add_u32 s36, s25, 2
    s_cmp_ge_u32 s4, 8
    s_cbranch_scc1 K1_ETTT_02_H
    s_and_b32 s37, s36, 15
    s_lshl_b32 s37, s37, 17
    s_lshl_b32 s38, s35, 10
    s_add_u32 s37, s37, s38
    s_mov_b32 s39, 1052289595
    s_mov_b32 s40, 0xff800000
    s_mov_b32 s41, 65536
    s_cmp_lt_u32 s36, 16
    s_cbranch_scc1 K1_ETTT_02_GO
    s_add_u32 s37, s37, 2097152
    s_mov_b32 s39, 1.0
    s_branch K1_ETTT_02_GO
K1_ETTT_02_H:
    s_cmp_ge_u32 s36, 43
    s_cbranch_scc1 K1_ETTT_02_SKIP
    s_mul_i32 s37, s35, 86
    s_lshl_b32 s38, s36, 1
    s_add_u32 s37, s37, s38
    s_lshl_b32 s37, s37, 10
    s_add_u32 s37, s37, 6291456
    s_mov_b32 s39, 1.0
    s_mov_b32 s40, 0
    s_movk_i32 s41, 1024
K1_ETTT_02_GO:
    v_mul_f32 v192, s39, v128
    v_max_f32 v192, s40, v192
    v_mul_f32 v193, s39, v129
    v_max_f32 v193, s40, v193
    v_mul_f32 v194, s39, v130
    v_max_f32 v194, s40, v194
    v_mul_f32 v195, s39, v131
    v_max_f32 v195, s40, v195
    v_mul_f32 v196, s39, v132
    v_max_f32 v196, s40, v196
    v_mul_f32 v197, s39, v133
    v_max_f32 v197, s40, v197
    v_mul_f32 v198, s39, v134
    v_max_f32 v198, s40, v198
    v_mul_f32 v199, s39, v135
    v_max_f32 v199, s40, v199
    v_cvt_pk_bf16_f32 v200, v192, v193
    v_cvt_pk_bf16_f32 v201, v194, v195
    v_cvt_pk_bf16_f32 v202, v196, v197
    v_cvt_pk_bf16_f32 v203, v198, v199
    buffer_store_dwordx4 v[200:203], v14, s[16:19], s37 offen
    s_nop 1
    v_mul_f32 v192, s39, v136
    v_max_f32 v192, s40, v192
    v_mul_f32 v193, s39, v137
    v_max_f32 v193, s40, v193
    v_mul_f32 v194, s39, v138
    v_max_f32 v194, s40, v194
    v_mul_f32 v195, s39, v139
    v_max_f32 v195, s40, v195
    v_mul_f32 v196, s39, v140
    v_max_f32 v196, s40, v196
    v_mul_f32 v197, s39, v141
    v_max_f32 v197, s40, v197
    v_mul_f32 v198, s39, v142
    v_max_f32 v198, s40, v198
    v_mul_f32 v199, s39, v143
    v_max_f32 v199, s40, v199
    v_cvt_pk_bf16_f32 v200, v192, v193
    v_cvt_pk_bf16_f32 v201, v194, v195
    v_cvt_pk_bf16_f32 v202, v196, v197
    v_cvt_pk_bf16_f32 v203, v198, v199
    s_add_u32 s37, s37, s41
    buffer_store_dwordx4 v[200:203], v14, s[16:19], s37 offen
    s_nop 1
K1_ETTT_02_SKIP:
    s_lshl_b32 s35, s3, 2
    s_lshl_b32 s36, s6, 1
    s_add_u32 s35, s35, s36
    s_add_u32 s35, s35, 1
    s_add_u32 s36, s25, 0
    s_cmp_ge_u32 s4, 8
    s_cbranch_scc1 K1_ETTT_10_H
    s_and_b32 s37, s36, 15
    s_lshl_b32 s37, s37, 17
    s_lshl_b32 s38, s35, 10
    s_add_u32 s37, s37, s38
    s_mov_b32 s39, 1052289595
    s_mov_b32 s40, 0xff800000
    s_mov_b32 s41, 65536
    s_cmp_lt_u32 s36, 16
    s_cbranch_scc1 K1_ETTT_10_GO
    s_add_u32 s37, s37, 2097152
    s_mov_b32 s39, 1.0
    s_branch K1_ETTT_10_GO
K1_ETTT_10_H:
    s_cmp_ge_u32 s36, 43
    s_cbranch_scc1 K1_ETTT_10_SKIP
    s_mul_i32 s37, s35, 86
    s_lshl_b32 s38, s36, 1
    s_add_u32 s37, s37, s38
    s_lshl_b32 s37, s37, 10
    s_add_u32 s37, s37, 6291456
    s_mov_b32 s39, 1.0
    s_mov_b32 s40, 0
    s_movk_i32 s41, 1024
K1_ETTT_10_GO:
    v_mul_f32 v192, s39, v144
    v_max_f32 v192, s40, v192
    v_mul_f32 v193, s39, v145
    v_max_f32 v193, s40, v193
    v_mul_f32 v194, s39, v146
    v_max_f32 v194, s40, v194
    v_mul_f32 v195, s39, v147
    v_max_f32 v195, s40, v195
    v_mul_f32 v196, s39, v148
    v_max_f32 v196, s40, v196
    v_mul_f32 v197, s39, v149
    v_max_f32 v197, s40, v197
    v_mul_f32 v198, s39, v150
    v_max_f32 v198, s40, v198
    v_mul_f32 v199, s39, v151
    v_max_f32 v199, s40, v199
    v_cvt_pk_bf16_f32 v200, v192, v193
    v_cvt_pk_bf16_f32 v201, v194, v195
    v_cvt_pk_bf16_f32 v202, v196, v197
    v_cvt_pk_bf16_f32 v203, v198, v199
    buffer_store_dwordx4 v[200:203], v14, s[16:19], s37 offen
    s_nop 1
    v_mul_f32 v192, s39, v152
    v_max_f32 v192, s40, v192
    v_mul_f32 v193, s39, v153
    v_max_f32 v193, s40, v193
    v_mul_f32 v194, s39, v154
    v_max_f32 v194, s40, v194
    v_mul_f32 v195, s39, v155
    v_max_f32 v195, s40, v195
    v_mul_f32 v196, s39, v156
    v_max_f32 v196, s40, v196
    v_mul_f32 v197, s39, v157
    v_max_f32 v197, s40, v197
    v_mul_f32 v198, s39, v158
    v_max_f32 v198, s40, v198
    v_mul_f32 v199, s39, v159
    v_max_f32 v199, s40, v199
    v_cvt_pk_bf16_f32 v200, v192, v193
    v_cvt_pk_bf16_f32 v201, v194, v195
    v_cvt_pk_bf16_f32 v202, v196, v197
    v_cvt_pk_bf16_f32 v203, v198, v199
    s_add_u32 s37, s37, s41
    buffer_store_dwordx4 v[200:203], v14, s[16:19], s37 offen
    s_nop 1
K1_ETTT_10_SKIP:
    s_lshl_b32 s35, s3, 2
    s_lshl_b32 s36, s6, 1
    s_add_u32 s35, s35, s36
    s_add_u32 s35, s35, 1
    s_add_u32 s36, s25, 1
    s_cmp_ge_u32 s4, 8
    s_cbranch_scc1 K1_ETTT_11_H
    s_and_b32 s37, s36, 15
    s_lshl_b32 s37, s37, 17
    s_lshl_b32 s38, s35, 10
    s_add_u32 s37, s37, s38
    s_mov_b32 s39, 1052289595
    s_mov_b32 s40, 0xff800000
    s_mov_b32 s41, 65536
    s_cmp_lt_u32 s36, 16
    s_cbranch_scc1 K1_ETTT_11_GO
    s_add_u32 s37, s37, 2097152
    s_mov_b32 s39, 1.0
    s_branch K1_ETTT_11_GO
K1_ETTT_11_H:
    s_cmp_ge_u32 s36, 43
    s_cbranch_scc1 K1_ETTT_11_SKIP
    s_mul_i32 s37, s35, 86
    s_lshl_b32 s38, s36, 1
    s_add_u32 s37, s37, s38
    s_lshl_b32 s37, s37, 10
    s_add_u32 s37, s37, 6291456
    s_mov_b32 s39, 1.0
    s_mov_b32 s40, 0
    s_movk_i32 s41, 1024
K1_ETTT_11_GO:
    v_mul_f32 v192, s39, v160
    v_max_f32 v192, s40, v192
    v_mul_f32 v193, s39, v161
    v_max_f32 v193, s40, v193
    v_mul_f32 v194, s39, v162
    v_max_f32 v194, s40, v194
    v_mul_f32 v195, s39, v163
    v_max_f32 v195, s40, v195
    v_mul_f32 v196, s39, v164
    v_max_f32 v196, s40, v196
    v_mul_f32 v197, s39, v165
    v_max_f32 v197, s40, v197
    v_mul_f32 v198, s39, v166
    v_max_f32 v198, s40, v198
    v_mul_f32 v199, s39, v167
    v_max_f32 v199, s40, v199
    v_cvt_pk_bf16_f32 v200, v192, v193
    v_cvt_pk_bf16_f32 v201, v194, v195
    v_cvt_pk_bf16_f32 v202, v196, v197
    v_cvt_pk_bf16_f32 v203, v198, v199
    buffer_store_dwordx4 v[200:203], v14, s[16:19], s37 offen
    s_nop 1
    v_mul_f32 v192, s39, v168
    v_max_f32 v192, s40, v192
    v_mul_f32 v193, s39, v169
    v_max_f32 v193, s40, v193
    v_mul_f32 v194, s39, v170
    v_max_f32 v194, s40, v194
    v_mul_f32 v195, s39, v171
    v_max_f32 v195, s40, v195
    v_mul_f32 v196, s39, v172
    v_max_f32 v196, s40, v196
    v_mul_f32 v197, s39, v173
    v_max_f32 v197, s40, v197
    v_mul_f32 v198, s39, v174
    v_max_f32 v198, s40, v198
    v_mul_f32 v199, s39, v175
    v_max_f32 v199, s40, v199
    v_cvt_pk_bf16_f32 v200, v192, v193
    v_cvt_pk_bf16_f32 v201, v194, v195
    v_cvt_pk_bf16_f32 v202, v196, v197
    v_cvt_pk_bf16_f32 v203, v198, v199
    s_add_u32 s37, s37, s41
    buffer_store_dwordx4 v[200:203], v14, s[16:19], s37 offen
    s_nop 1
K1_ETTT_11_SKIP:
    s_lshl_b32 s35, s3, 2
    s_lshl_b32 s36, s6, 1
    s_add_u32 s35, s35, s36
    s_add_u32 s35, s35, 1
    s_add_u32 s36, s25, 2
    s_cmp_ge_u32 s4, 8
    s_cbranch_scc1 K1_ETTT_12_H
    s_and_b32 s37, s36, 15
    s_lshl_b32 s37, s37, 17
    s_lshl_b32 s38, s35, 10
    s_add_u32 s37, s37, s38
    s_mov_b32 s39, 1052289595
    s_mov_b32 s40, 0xff800000
    s_mov_b32 s41, 65536
    s_cmp_lt_u32 s36, 16
    s_cbranch_scc1 K1_ETTT_12_GO
    s_add_u32 s37, s37, 2097152
    s_mov_b32 s39, 1.0
    s_branch K1_ETTT_12_GO
K1_ETTT_12_H:
    s_cmp_ge_u32 s36, 43
    s_cbranch_scc1 K1_ETTT_12_SKIP
    s_mul_i32 s37, s35, 86
    s_lshl_b32 s38, s36, 1
    s_add_u32 s37, s37, s38
    s_lshl_b32 s37, s37, 10
    s_add_u32 s37, s37, 6291456
    s_mov_b32 s39, 1.0
    s_mov_b32 s40, 0
    s_movk_i32 s41, 1024
K1_ETTT_12_GO:
    v_mul_f32 v192, s39, v176
    v_max_f32 v192, s40, v192
    v_mul_f32 v193, s39, v177
    v_max_f32 v193, s40, v193
    v_mul_f32 v194, s39, v178
    v_max_f32 v194, s40, v194
    v_mul_f32 v195, s39, v179
    v_max_f32 v195, s40, v195
    v_mul_f32 v196, s39, v180
    v_max_f32 v196, s40, v196
    v_mul_f32 v197, s39, v181
    v_max_f32 v197, s40, v197
    v_mul_f32 v198, s39, v182
    v_max_f32 v198, s40, v198
    v_mul_f32 v199, s39, v183
    v_max_f32 v199, s40, v199
    v_cvt_pk_bf16_f32 v200, v192, v193
    v_cvt_pk_bf16_f32 v201, v194, v195
    v_cvt_pk_bf16_f32 v202, v196, v197
    v_cvt_pk_bf16_f32 v203, v198, v199
    buffer_store_dwordx4 v[200:203], v14, s[16:19], s37 offen
    s_nop 1
    v_mul_f32 v192, s39, v184
    v_max_f32 v192, s40, v192
    v_mul_f32 v193, s39, v185
    v_max_f32 v193, s40, v193
    v_mul_f32 v194, s39, v186
    v_max_f32 v194, s40, v194
    v_mul_f32 v195, s39, v187
    v_max_f32 v195, s40, v195
    v_mul_f32 v196, s39, v188
    v_max_f32 v196, s40, v196
    v_mul_f32 v197, s39, v189
    v_max_f32 v197, s40, v197
    v_mul_f32 v198, s39, v190
    v_max_f32 v198, s40, v198
    v_mul_f32 v199, s39, v191
    v_max_f32 v199, s40, v199
    v_cvt_pk_bf16_f32 v200, v192, v193
    v_cvt_pk_bf16_f32 v201, v194, v195
    v_cvt_pk_bf16_f32 v202, v196, v197
    v_cvt_pk_bf16_f32 v203, v198, v199
    s_add_u32 s37, s37, s41
    buffer_store_dwordx4 v[200:203], v14, s[16:19], s37 offen
    s_nop 1
K1_ETTT_12_SKIP:
    s_branch K1_END
K1_TTN:
    s_mov_b32 s24, 0
K1_LTTN:
    s_add_u32 s21, s21, 128
    s_add_u32 s22, s22, s23
    buffer_load_dwordx4 v[16:19], v2, s[8:11], s21 offen
    buffer_load_dwordx4 v[20:23], v3, s[8:11], s21 offen
    buffer_load_dwordx4 v[24:27], v4, s[8:11], s21 offen
    buffer_load_dwordx4 v[28:31], v5, s[8:11], s21 offen
    buffer_load_dwordx4 v[32:35], v6, s[12:15], s22 offen offset:0
    buffer_load_dwordx4 v[36:39], v6, s[12:15], s22 offen offset:128
    buffer_load_dwordx4 v[40:43], v6, s[12:15], s22 offen offset:256
    buffer_load_dwordx4 v[44:47], v7, s[12:15], s22 offen offset:0
    buffer_load_dwordx4 v[48:51], v7, s[12:15], s22 offen offset:128
    buffer_load_dwordx4 v[52:55], v7, s[12:15], s22 offen offset:256
    ds_read_b128 v[56:59], v10 offset:0
    ds_read_b128 v[60:63], v10 offset:4608
    ds_read_b64_tr_b16 v[64:65], v12 offset:0
    ds_read_b64_tr_b16 v[66:67], v12 offset:1792
    ds_read_b64_tr_b16 v[68:69], v12 offset:64
    ds_read_b64_tr_b16 v[70:71], v12 offset:1856
    ds_read_b64_tr_b16 v[72:73], v12 offset:128
    ds_read_b64_tr_b16 v[74:75], v12 offset:1920
    ds_read_b128 v[76:79], v10 offset:32
    ds_read_b128 v[80:83], v10 offset:4640
    ds_read_b64_tr_b16 v[84:85], v12 offset:7168
    ds_read_b64_tr_b16 v[86:87], v12 offset:8960
    ds_read_b64_tr_b16 v[88:89], v12 offset:7232
    ds_read_b64_tr_b16 v[90:91], v12 offset:9024
    ds_read_b64_tr_b16 v[92:93], v12 offset:7296
    ds_read_b64_tr_b16 v[94:95], v12 offset:9088
    s_waitcnt lgkmcnt(8)
    v_mfma_f32_32x32x16_bf16 v[96:111], v[64:67], v[56:59], v[96:111]
    v_mfma_f32_32x32x16_bf16 v[112:127], v[68:71], v[56:59], v[112:127]
    v_mfma_f32_32x32x16_bf16 v[128:143], v[56:59], v[72:75], v[128:143]
    v_mfma_f32_32x32x16_bf16 v[144:159], v[64:67], v[60:63], v[144:159]
    v_mfma_f32_32x32x16_bf16 v[160:175], v[68:71], v[60:63], v[160:175]
    v_mfma_f32_32x32x16_bf16 v[176:191], v[60:63], v[72:75], v[176:191]
    ds_read_b128 v[56:59], v10 offset:64
    ds_read_b128 v[60:63], v10 offset:4672
    ds_read_b64_tr_b16 v[64:65], v12 offset:14336
    ds_read_b64_tr_b16 v[66:67], v12 offset:16128
    ds_read_b64_tr_b16 v[68:69], v12 offset:14400
    ds_read_b64_tr_b16 v[70:71], v12 offset:16192
    ds_read_b64_tr_b16 v[72:73], v12 offset:14464
    ds_read_b64_tr_b16 v[74:75], v12 offset:16256
    s_waitcnt lgkmcnt(8)
    v_mfma_f32_32x32x16_bf16 v[96:111], v[84:87], v[76:79], v[96:111]
    v_mfma_f32_32x32x16_bf16 v[112:127], v[88:91], v[76:79], v[112:127]
    v_mfma_f32_32x32x16_bf16 v[128:143], v[76:79], v[92:95], v[128:143]
    v_mfma_f32_32x32x16_bf16 v[144:159], v[84:87], v[80:83], v[144:159]
    v_mfma_f32_32x32x16_bf16 v[160:175], v[88:91], v[80:83], v[160:175]
    v_mfma_f32_32x32x16_bf16 v[176:191], v[80:83], v[92:95], v[176:191]
    ds_read_b128 v[76:79], v10 offset:96
    ds_read_b128 v[80:83], v10 offset:4704
    ds_read_b64_tr_b16 v[84:85], v12 offset:21504
    ds_read_b64_tr_b16 v[86:87], v12 offset:23296
    ds_read_b64_tr_b16 v[88:89], v12 offset:21568
    ds_read_b64_tr_b16 v[90:91], v12 offset:23360
    ds_read_b64_tr_b16 v[92:93], v12 offset:21632
    ds_read_b64_tr_b16 v[94:95], v12 offset:23424
    s_waitcnt lgkmcnt(8)
    v_mfma_f32_32x32x16_bf16 v[96:111], v[64:67], v[56:59], v[96:111]
    v_mfma_f32_32x32x16_bf16 v[112:127], v[68:71], v[56:59], v[112:127]
    v_mfma_f32_32x32x16_bf16 v[128:143], v[56:59], v[72:75], v[128:143]
    v_mfma_f32_32x32x16_bf16 v[144:159], v[64:67], v[60:63], v[144:159]
    v_mfma_f32_32x32x16_bf16 v[160:175], v[68:71], v[60:63], v[160:175]
    v_mfma_f32_32x32x16_bf16 v[176:191], v[60:63], v[72:75], v[176:191]
    s_waitcnt lgkmcnt(0)
    v_mfma_f32_32x32x16_bf16 v[96:111], v[84:87], v[76:79], v[96:111]
    v_mfma_f32_32x32x16_bf16 v[112:127], v[88:91], v[76:79], v[112:127]
    v_mfma_f32_32x32x16_bf16 v[128:143], v[76:79], v[92:95], v[128:143]
    v_mfma_f32_32x32x16_bf16 v[144:159], v[84:87], v[80:83], v[144:159]
    v_mfma_f32_32x32x16_bf16 v[160:175], v[88:91], v[80:83], v[160:175]
    v_mfma_f32_32x32x16_bf16 v[176:191], v[80:83], v[92:95], v[176:191]
    s_waitcnt vmcnt(0)
    ds_write_b128 v8, v[16:19] offset:47104
    ds_write_b128 v8, v[20:23] offset:51712
    ds_write_b128 v8, v[24:27] offset:56320
    ds_write_b128 v8, v[28:31] offset:60928
    ds_write_b128 v9, v[32:35] offset:47104
    ds_write_b128 v9, v[36:39] offset:47232
    ds_write_b128 v9, v[40:43] offset:47360
    ds_write_b128 v9, v[44:47] offset:61440
    ds_write_b128 v9, v[48:51] offset:61568
    ds_write_b128 v9, v[52:55] offset:61696
    s_waitcnt lgkmcnt(0)
    s_barrier
    s_add_u32 s21, s21, 128
    s_add_u32 s22, s22, s23
    buffer_load_dwordx4 v[16:19], v2, s[8:11], s21 offen
    buffer_load_dwordx4 v[20:23], v3, s[8:11], s21 offen
    buffer_load_dwordx4 v[24:27], v4, s[8:11], s21 offen
    buffer_load_dwordx4 v[28:31], v5, s[8:11], s21 offen
    buffer_load_dwordx4 v[32:35], v6, s[12:15], s22 offen offset:0
    buffer_load_dwordx4 v[36:39], v6, s[12:15], s22 offen offset:128
    buffer_load_dwordx4 v[40:43], v6, s[12:15], s22 offen offset:256
    buffer_load_dwordx4 v[44:47], v7, s[12:15], s22 offen offset:0
    buffer_load_dwordx4 v[48:51], v7, s[12:15], s22 offen offset:128
    buffer_load_dwordx4 v[52:55], v7, s[12:15], s22 offen offset:256
    ds_read_b128 v[56:59], v11 offset:0
    ds_read_b128 v[60:63], v11 offset:4608
    ds_read_b64_tr_b16 v[64:65], v13 offset:0
    ds_read_b64_tr_b16 v[66:67], v13 offset:1792
    ds_read_b64_tr_b16 v[68:69], v13 offset:64
    ds_read_b64_tr_b16 v[70:71], v13 offset:1856
    ds_read_b64_tr_b16 v[72:73], v13 offset:128
    ds_read_b64_tr_b16 v[74:75], v13 offset:1920
    ds_read_b128 v[76:79], v11 offset:32
    ds_read_b128 v[80:83], v11 offset:4640
    ds_read_b64_tr_b16 v[84:85], v13 offset:7168
    ds_read_b64_tr_b16 v[86:87], v13 offset:8960
    ds_read_b64_tr_b16 v[88:89], v13 offset:7232
    ds_read_b64_tr_b16 v[90:91], v13 offset:9024
    ds_read_b64_tr_b16 v[92:93], v13 offset:7296
    ds_read_b64_tr_b16 v[94:95], v13 offset:9088
    s_waitcnt lgkmcnt(8)
    v_mfma_f32_32x32x16_bf16 v[96:111], v[64:67], v[56:59], v[96:111]
    v_mfma_f32_32x32x16_bf16 v[112:127], v[68:71], v[56:59], v[112:127]
    v_mfma_f32_32x32x16_bf16 v[128:143], v[56:59], v[72:75], v[128:143]
    v_mfma_f32_32x32x16_bf16 v[144:159], v[64:67], v[60:63], v[144:159]
    v_mfma_f32_32x32x16_bf16 v[160:175], v[68:71], v[60:63], v[160:175]
    v_mfma_f32_32x32x16_bf16 v[176:191], v[60:63], v[72:75], v[176:191]
    ds_read_b128 v[56:59], v11 offset:64
    ds_read_b128 v[60:63], v11 offset:4672
    ds_read_b64_tr_b16 v[64:65], v13 offset:14336
    ds_read_b64_tr_b16 v[66:67], v13 offset:16128
    ds_read_b64_tr_b16 v[68:69], v13 offset:14400
    ds_read_b64_tr_b16 v[70:71], v13 offset:16192
    ds_read_b64_tr_b16 v[72:73], v13 offset:14464
    ds_read_b64_tr_b16 v[74:75], v13 offset:16256
    s_waitcnt lgkmcnt(8)
    v_mfma_f32_32x32x16_bf16 v[96:111], v[84:87], v[76:79], v[96:111]
    v_mfma_f32_32x32x16_bf16 v[112:127], v[88:91], v[76:79], v[112:127]
    v_mfma_f32_32x32x16_bf16 v[128:143], v[76:79], v[92:95], v[128:143]
    v_mfma_f32_32x32x16_bf16 v[144:159], v[84:87], v[80:83], v[144:159]
    v_mfma_f32_32x32x16_bf16 v[160:175], v[88:91], v[80:83], v[160:175]
    v_mfma_f32_32x32x16_bf16 v[176:191], v[80:83], v[92:95], v[176:191]
    ds_read_b128 v[76:79], v11 offset:96
    ds_read_b128 v[80:83], v11 offset:4704
    ds_read_b64_tr_b16 v[84:85], v13 offset:21504
    ds_read_b64_tr_b16 v[86:87], v13 offset:23296
    ds_read_b64_tr_b16 v[88:89], v13 offset:21568
    ds_read_b64_tr_b16 v[90:91], v13 offset:23360
    ds_read_b64_tr_b16 v[92:93], v13 offset:21632
    ds_read_b64_tr_b16 v[94:95], v13 offset:23424
    s_waitcnt lgkmcnt(8)
    v_mfma_f32_32x32x16_bf16 v[96:111], v[64:67], v[56:59], v[96:111]
    v_mfma_f32_32x32x16_bf16 v[112:127], v[68:71], v[56:59], v[112:127]
    v_mfma_f32_32x32x16_bf16 v[128:143], v[56:59], v[72:75], v[128:143]
    v_mfma_f32_32x32x16_bf16 v[144:159], v[64:67], v[60:63], v[144:159]
    v_mfma_f32_32x32x16_bf16 v[160:175], v[68:71], v[60:63], v[160:175]
    v_mfma_f32_32x32x16_bf16 v[176:191], v[60:63], v[72:75], v[176:191]
    s_waitcnt lgkmcnt(0)
    v_mfma_f32_32x32x16_bf16 v[96:111], v[84:87], v[76:79], v[96:111]
    v_mfma_f32_32x32x16_bf16 v[112:127], v[88:91], v[76:79], v[112:127]
    v_mfma_f32_32x32x16_bf16 v[128:143], v[76:79], v[92:95], v[128:143]
    v_mfma_f32_32x32x16_bf16 v[144:159], v[84:87], v[80:83], v[144:159]
    v_mfma_f32_32x32x16_bf16 v[160:175], v[88:91], v[80:83], v[160:175]
    v_mfma_f32_32x32x16_bf16 v[176:191], v[80:83], v[92:95], v[176:191]
    s_waitcnt vmcnt(0)
    ds_write_b128 v8, v[16:19] offset:0
    ds_write_b128 v8, v[20:23] offset:4608
    ds_write_b128 v8, v[24:27] offset:9216
    ds_write_b128 v8, v[28:31] offset:13824
    ds_write_b128 v9, v[32:35] offset:0
    ds_write_b128 v9, v[36:39] offset:128
    ds_write_b128 v9, v[40:43] offset:256
    ds_write_b128 v9, v[44:47] offset:14336
    ds_write_b128 v9, v[48:51] offset:14464
    ds_write_b128 v9, v[52:55] offset:14592
    s_waitcnt lgkmcnt(0)
    s_barrier
    s_add_u32 s24, s24, 1
    s_cmp_lt_u32 s24, 4
    s_cbranch_scc1 K1_LTTN
    s_nop 7
    s_nop 7
    v_lshlrev_b32 v14, 4, v1
    s_lshl_b32 s35, s3, 2
    s_lshl_b32 s36, s6, 1
    s_add_u32 s35, s35, s36
    s_add_u32 s35, s35, 0
    s_add_u32 s36, s25, 0
    s_cmp_ge_u32 s4, 8
    s_cbranch_scc1 K1_ETTN_00_H
    s_and_b32 s37, s36, 15
    s_lshl_b32 s37, s37, 17
    s_lshl_b32 s38, s35, 10
    s_add_u32 s37, s37, s38
    s_mov_b32 s39, 1052289595
    s_mov_b32 s40, 0xff800000
    s_mov_b32 s41, 65536
    s_cmp_lt_u32 s36, 16
    s_cbranch_scc1 K1_ETTN_00_GO
    s_add_u32 s37, s37, 2097152
    s_mov_b32 s39, 1.0
    s_branch K1_ETTN_00_GO
K1_ETTN_00_H:
    s_cmp_ge_u32 s36, 43
    s_cbranch_scc1 K1_ETTN_00_SKIP
    s_mul_i32 s37, s35, 86
    s_lshl_b32 s38, s36, 1
    s_add_u32 s37, s37, s38
    s_lshl_b32 s37, s37, 10
    s_add_u32 s37, s37, 6291456
    s_mov_b32 s39, 1.0
    s_mov_b32 s40, 0
    s_movk_i32 s41, 1024
K1_ETTN_00_GO:
    v_mul_f32 v192, s39, v96
    v_max_f32 v192, s40, v192
    v_mul_f32 v193, s39, v97
    v_max_f32 v193, s40, v193
    v_mul_f32 v194, s39, v98
    v_max_f32 v194, s40, v194
    v_mul_f32 v195, s39, v99
    v_max_f32 v195, s40, v195
    v_mul_f32 v196, s39, v100
    v_max_f32 v196, s40, v196
    v_mul_f32 v197, s39, v101
    v_max_f32 v197, s40, v197
    v_mul_f32 v198, s39, v102
    v_max_f32 v198, s40, v198
    v_mul_f32 v199, s39, v103
    v_max_f32 v199, s40, v199
    v_cvt_pk_bf16_f32 v200, v192, v193
    v_cvt_pk_bf16_f32 v201, v194, v195
    v_cvt_pk_bf16_f32 v202, v196, v197
    v_cvt_pk_bf16_f32 v203, v198, v199
    buffer_store_dwordx4 v[200:203], v14, s[16:19], s37 offen
    s_nop 1
    v_mul_f32 v192, s39, v104
    v_max_f32 v192, s40, v192
    v_mul_f32 v193, s39, v105
    v_max_f32 v193, s40, v193
    v_mul_f32 v194, s39, v106
    v_max_f32 v194, s40, v194
    v_mul_f32 v195, s39, v107
    v_max_f32 v195, s40, v195
    v_mul_f32 v196, s39, v108
    v_max_f32 v196, s40, v196
    v_mul_f32 v197, s39, v109
    v_max_f32 v197, s40, v197
    v_mul_f32 v198, s39, v110
    v_max_f32 v198, s40, v198
    v_mul_f32 v199, s39, v111
    v_max_f32 v199, s40, v199
    v_cvt_pk_bf16_f32 v200, v192, v193
    v_cvt_pk_bf16_f32 v201, v194, v195
    v_cvt_pk_bf16_f32 v202, v196, v197
    v_cvt_pk_bf16_f32 v203, v198, v199
    s_add_u32 s37, s37, s41
    buffer_store_dwordx4 v[200:203], v14, s[16:19], s37 offen
    s_nop 1
K1_ETTN_00_SKIP:
    s_lshl_b32 s35, s3, 2
    s_lshl_b32 s36, s6, 1
    s_add_u32 s35, s35, s36
    s_add_u32 s35, s35, 0
    s_add_u32 s36, s25, 1
    s_cmp_ge_u32 s4, 8
    s_cbranch_scc1 K1_ETTN_01_H
    s_and_b32 s37, s36, 15
    s_lshl_b32 s37, s37, 17
    s_lshl_b32 s38, s35, 10
    s_add_u32 s37, s37, s38
    s_mov_b32 s39, 1052289595
    s_mov_b32 s40, 0xff800000
    s_mov_b32 s41, 65536
    s_cmp_lt_u32 s36, 16
    s_cbranch_scc1 K1_ETTN_01_GO
    s_add_u32 s37, s37, 2097152
    s_mov_b32 s39, 1.0
    s_branch K1_ETTN_01_GO
K1_ETTN_01_H:
    s_cmp_ge_u32 s36, 43
    s_cbranch_scc1 K1_ETTN_01_SKIP
    s_mul_i32 s37, s35, 86
    s_lshl_b32 s38, s36, 1
    s_add_u32 s37, s37, s38
    s_lshl_b32 s37, s37, 10
    s_add_u32 s37, s37, 6291456
    s_mov_b32 s39, 1.0
    s_mov_b32 s40, 0
    s_movk_i32 s41, 1024
K1_ETTN_01_GO:
    v_mul_f32 v192, s39, v112
    v_max_f32 v192, s40, v192
    v_mul_f32 v193, s39, v113
    v_max_f32 v193, s40, v193
    v_mul_f32 v194, s39, v114
    v_max_f32 v194, s40, v194
    v_mul_f32 v195, s39, v115
    v_max_f32 v195, s40, v195
    v_mul_f32 v196, s39, v116
    v_max_f32 v196, s40, v196
    v_mul_f32 v197, s39, v117
    v_max_f32 v197, s40, v197
    v_mul_f32 v198, s39, v118
    v_max_f32 v198, s40, v198
    v_mul_f32 v199, s39, v119
    v_max_f32 v199, s40, v199
    v_cvt_pk_bf16_f32 v200, v192, v193
    v_cvt_pk_bf16_f32 v201, v194, v195
    v_cvt_pk_bf16_f32 v202, v196, v197
    v_cvt_pk_bf16_f32 v203, v198, v199
    buffer_store_dwordx4 v[200:203], v14, s[16:19], s37 offen
    s_nop 1
    v_mul_f32 v192, s39, v120
    v_max_f32 v192, s40, v192
    v_mul_f32 v193, s39, v121
    v_max_f32 v193, s40, v193
    v_mul_f32 v194, s39, v122
    v_max_f32 v194, s40, v194
    v_mul_f32 v195, s39, v123
    v_max_f32 v195, s40, v195
    v_mul_f32 v196, s39, v124
    v_max_f32 v196, s40, v196
    v_mul_f32 v197, s39, v125
    v_max_f32 v197, s40, v197
    v_mul_f32 v198, s39, v126
    v_max_f32 v198, s40, v198
    v_mul_f32 v199, s39, v127
    v_max_f32 v199, s40, v199
    v_cvt_pk_bf16_f32 v200, v192, v193
    v_cvt_pk_bf16_f32 v201, v194, v195
    v_cvt_pk_bf16_f32 v202, v196, v197
    v_cvt_pk_bf16_f32 v203, v198, v199
    s_add_u32 s37, s37, s41
    buffer_store_dwordx4 v[200:203], v14, s[16:19], s37 offen
    s_nop 1
K1_ETTN_01_SKIP:
    s_lshl_b32 s35, s3, 2
    s_lshl_b32 s36, s6, 1
    s_add_u32 s35, s35, s36
    s_add_u32 s35, s35, 0
    s_add_u32 s36, s25, 2
    s_sub_u32 s37, s36, 32
    s_lshl_b32 s37, s37, 17
    s_lshl_b32 s38, s35, 10
    s_add_u32 s37, s37, s38
    s_add_u32 s37, s37, 4194304
    v_bfe_u32 v15, v1, 4, 1
    v_lshlrev_b32 v15, 16, v15
    v_lshrrev_b32 v16, 5, v1
    v_lshl_add_u32 v15, v16, 8, v15
    v_and_b32 v16, 15, v1
    v_lshl_add_u32 v15, v16, 4, v15
    v_cvt_pk_bf16_f32 v200, v128, v129
    v_cvt_pk_bf16_f32 v201, v130, v131
    v_cvt_pk_bf16_f32 v202, v132, v133
    v_cvt_pk_bf16_f32 v203, v134, v135
    buffer_store_dwordx4 v[200:203], v15, s[16:19], s37 offen offset:0
    s_nop 1
    v_cvt_pk_bf16_f32 v200, v136, v137
    v_cvt_pk_bf16_f32 v201, v138, v139
    v_cvt_pk_bf16_f32 v202, v140, v141
    v_cvt_pk_bf16_f32 v203, v142, v143
    buffer_store_dwordx4 v[200:203], v15, s[16:19], s37 offen offset:512
    s_nop 1
    s_lshl_b32 s35, s3, 2
    s_lshl_b32 s36, s6, 1
    s_add_u32 s35, s35, s36
    s_add_u32 s35, s35, 1
    s_add_u32 s36, s25, 0
    s_cmp_ge_u32 s4, 8
    s_cbranch_scc1 K1_ETTN_10_H
    s_and_b32 s37, s36, 15
    s_lshl_b32 s37, s37, 17
    s_lshl_b32 s38, s35, 10
    s_add_u32 s37, s37, s38
    s_mov_b32 s39, 1052289595
    s_mov_b32 s40, 0xff800000
    s_mov_b32 s41, 65536
    s_cmp_lt_u32 s36, 16
    s_cbranch_scc1 K1_ETTN_10_GO
    s_add_u32 s37, s37, 2097152
    s_mov_b32 s39, 1.0
    s_branch K1_ETTN_10_GO
K1_ETTN_10_H:
    s_cmp_ge_u32 s36, 43
    s_cbranch_scc1 K1_ETTN_10_SKIP
    s_mul_i32 s37, s35, 86
    s_lshl_b32 s38, s36, 1
    s_add_u32 s37, s37, s38
    s_lshl_b32 s37, s37, 10
    s_add_u32 s37, s37, 6291456
    s_mov_b32 s39, 1.0
    s_mov_b32 s40, 0
    s_movk_i32 s41, 1024
K1_ETTN_10_GO:
    v_mul_f32 v192, s39, v144
    v_max_f32 v192, s40, v192
    v_mul_f32 v193, s39, v145
    v_max_f32 v193, s40, v193
    v_mul_f32 v194, s39, v146
    v_max_f32 v194, s40, v194
    v_mul_f32 v195, s39, v147
    v_max_f32 v195, s40, v195
    v_mul_f32 v196, s39, v148
    v_max_f32 v196, s40, v196
    v_mul_f32 v197, s39, v149
    v_max_f32 v197, s40, v197
    v_mul_f32 v198, s39, v150
    v_max_f32 v198, s40, v198
    v_mul_f32 v199, s39, v151
    v_max_f32 v199, s40, v199
    v_cvt_pk_bf16_f32 v200, v192, v193
    v_cvt_pk_bf16_f32 v201, v194, v195
    v_cvt_pk_bf16_f32 v202, v196, v197
    v_cvt_pk_bf16_f32 v203, v198, v199
    buffer_store_dwordx4 v[200:203], v14, s[16:19], s37 offen
    s_nop 1
    v_mul_f32 v192, s39, v152
    v_max_f32 v192, s40, v192
    v_mul_f32 v193, s39, v153
    v_max_f32 v193, s40, v193
    v_mul_f32 v194, s39, v154
    v_max_f32 v194, s40, v194
    v_mul_f32 v195, s39, v155
    v_max_f32 v195, s40, v195
    v_mul_f32 v196, s39, v156
    v_max_f32 v196, s40, v196
    v_mul_f32 v197, s39, v157
    v_max_f32 v197, s40, v197
    v_mul_f32 v198, s39, v158
    v_max_f32 v198, s40, v198
    v_mul_f32 v199, s39, v159
    v_max_f32 v199, s40, v199
    v_cvt_pk_bf16_f32 v200, v192, v193
    v_cvt_pk_bf16_f32 v201, v194, v195
    v_cvt_pk_bf16_f32 v202, v196, v197
    v_cvt_pk_bf16_f32 v203, v198, v199
    s_add_u32 s37, s37, s41
    buffer_store_dwordx4 v[200:203], v14, s[16:19], s37 offen
    s_nop 1
K1_ETTN_10_SKIP:
    s_lshl_b32 s35, s3, 2
    s_lshl_b32 s36, s6, 1
    s_add_u32 s35, s35, s36
    s_add_u32 s35, s35, 1
    s_add_u32 s36, s25, 1
    s_cmp_ge_u32 s4, 8
    s_cbranch_scc1 K1_ETTN_11_H
    s_and_b32 s37, s36, 15
    s_lshl_b32 s37, s37, 17
    s_lshl_b32 s38, s35, 10
    s_add_u32 s37, s37, s38
    s_mov_b32 s39, 1052289595
    s_mov_b32 s40, 0xff800000
    s_mov_b32 s41, 65536
    s_cmp_lt_u32 s36, 16
    s_cbranch_scc1 K1_ETTN_11_GO
    s_add_u32 s37, s37, 2097152
    s_mov_b32 s39, 1.0
    s_branch K1_ETTN_11_GO
K1_ETTN_11_H:
    s_cmp_ge_u32 s36, 43
    s_cbranch_scc1 K1_ETTN_11_SKIP
    s_mul_i32 s37, s35, 86
    s_lshl_b32 s38, s36, 1
    s_add_u32 s37, s37, s38
    s_lshl_b32 s37, s37, 10
    s_add_u32 s37, s37, 6291456
    s_mov_b32 s39, 1.0
    s_mov_b32 s40, 0
    s_movk_i32 s41, 1024
K1_ETTN_11_GO:
    v_mul_f32 v192, s39, v160
    v_max_f32 v192, s40, v192
    v_mul_f32 v193, s39, v161
    v_max_f32 v193, s40, v193
    v_mul_f32 v194, s39, v162
    v_max_f32 v194, s40, v194
    v_mul_f32 v195, s39, v163
    v_max_f32 v195, s40, v195
    v_mul_f32 v196, s39, v164
    v_max_f32 v196, s40, v196
    v_mul_f32 v197, s39, v165
    v_max_f32 v197, s40, v197
    v_mul_f32 v198, s39, v166
    v_max_f32 v198, s40, v198
    v_mul_f32 v199, s39, v167
    v_max_f32 v199, s40, v199
    v_cvt_pk_bf16_f32 v200, v192, v193
    v_cvt_pk_bf16_f32 v201, v194, v195
    v_cvt_pk_bf16_f32 v202, v196, v197
    v_cvt_pk_bf16_f32 v203, v198, v199
    buffer_store_dwordx4 v[200:203], v14, s[16:19], s37 offen
    s_nop 1
    v_mul_f32 v192, s39, v168
    v_max_f32 v192, s40, v192
    v_mul_f32 v193, s39, v169
    v_max_f32 v193, s40, v193
    v_mul_f32 v194, s39, v170
    v_max_f32 v194, s40, v194
    v_mul_f32 v195, s39, v171
    v_max_f32 v195, s40, v195
    v_mul_f32 v196, s39, v172
    v_max_f32 v196, s40, v196
    v_mul_f32 v197, s39, v173
    v_max_f32 v197, s40, v197
    v_mul_f32 v198, s39, v174
    v_max_f32 v198, s40, v198
    v_mul_f32 v199, s39, v175
    v_max_f32 v199, s40, v199
    v_cvt_pk_bf16_f32 v200, v192, v193
    v_cvt_pk_bf16_f32 v201, v194, v195
    v_cvt_pk_bf16_f32 v202, v196, v197
    v_cvt_pk_bf16_f32 v203, v198, v199
    s_add_u32 s37, s37, s41
    buffer_store_dwordx4 v[200:203], v14, s[16:19], s37 offen
    s_nop 1
K1_ETTN_11_SKIP:
    s_lshl_b32 s35, s3, 2
    s_lshl_b32 s36, s6, 1
    s_add_u32 s35, s35, s36
    s_add_u32 s35, s35, 1
    s_add_u32 s36, s25, 2
    s_sub_u32 s37, s36, 32
    s_lshl_b32 s37, s37, 17
    s_lshl_b32 s38, s35, 10
    s_add_u32 s37, s37, s38
    s_add_u32 s37, s37, 4194304
    v_bfe_u32 v15, v1, 4, 1
    v_lshlrev_b32 v15, 16, v15
    v_lshrrev_b32 v16, 5, v1
    v_lshl_add_u32 v15, v16, 8, v15
    v_and_b32 v16, 15, v1
    v_lshl_add_u32 v15, v16, 4, v15
    v_cvt_pk_bf16_f32 v200, v176, v177
    v_cvt_pk_bf16_f32 v201, v178, v179
    v_cvt_pk_bf16_f32 v202, v180, v181
    v_cvt_pk_bf16_f32 v203, v182, v183
    buffer_store_dwordx4 v[200:203], v15, s[16:19], s37 offen offset:0
    s_nop 1
    v_cvt_pk_bf16_f32 v200, v184, v185
    v_cvt_pk_bf16_f32 v201, v186, v187
    v_cvt_pk_bf16_f32 v202, v188, v189
    v_cvt_pk_bf16_f32 v203, v190, v191
    buffer_store_dwordx4 v[200:203], v15, s[16:19], s37 offen offset:512
    s_nop 1
    s_branch K1_END
K1_NNN:
    s_mov_b32 s24, 0
K1_LNNN:
    s_add_u32 s21, s21, 128
    s_add_u32 s22, s22, s23
    buffer_load_dwordx4 v[16:19], v2, s[8:11], s21 offen
    buffer_load_dwordx4 v[20:23], v3, s[8:11], s21 offen
    buffer_load_dwordx4 v[24:27], v4, s[8:11], s21 offen
    buffer_load_dwordx4 v[28:31], v5, s[8:11], s21 offen
    buffer_load_dwordx4 v[32:35], v6, s[12:15], s22 offen offset:0
    buffer_load_dwordx4 v[36:39], v6, s[12:15], s22 offen offset:128
    buffer_load_dwordx4 v[40:43], v6, s[12:15], s22 offen offset:256
    buffer_load_dwordx4 v[44:47], v7, s[12:15], s22 offen offset:0
    buffer_load_dwordx4 v[48:51], v7, s[12:15], s22 offen offset:128
    buffer_load_dwordx4 v[52:55], v7, s[12:15], s22 offen offset:256
    ds_read_b128 v[56:59], v10 offset:0
    ds_read_b128 v[60:63], v10 offset:4608
    ds_read_b64_tr_b16 v[64:65], v12 offset:0
    ds_read_b64_tr_b16 v[66:67], v12 offset:1792
    ds_read_b64_tr_b16 v[68:69], v12 offset:64
    ds_read_b64_tr_b16 v[70:71], v12 offset:1856
    ds_read_b64_tr_b16 v[72:73], v12 offset:128
    ds_read_b64_tr_b16 v[74:75], v12 offset:1920
    ds_read_b128 v[76:79], v10 offset:32
    ds_read_b128 v[80:83], v10 offset:4640
    ds_read_b64_tr_b16 v[84:85], v12 offset:7168
    ds_read_b64_tr_b16 v[86:87], v12 offset:8960
    ds_read_b64_tr_b16 v[88:89], v12 offset:7232
    ds_read_b64_tr_b16 v[90:91], v12 offset:9024
    ds_read_b64_tr_b16 v[92:93], v12 offset:7296
    ds_read_b64_tr_b16 v[94:95], v12 offset:9088
    s_waitcnt lgkmcnt(8)
    v_mfma_f32_32x32x16_bf16 v[96:111], v[56:59], v[64:67], v[96:111]
    v_mfma_f32_32x32x16_bf16 v[112:127], v[56:59], v[68:71], v[112:127]
    v_mfma_f32_32x32x16_bf16 v[128:143], v[56:59], v[72:75], v[128:143]
    v_mfma_f32_32x32x16_bf16 v[144:159], v[60:63], v[64:67], v[144:159]
    v_mfma_f32_32x32x16_bf16 v[160:175], v[60:63], v[68:71], v[160:175]
    v_mfma_f32_32x32x16_bf16 v[176:191], v[60:63], v[72:75], v[176:191]
    ds_read_b128 v[56:59], v10 offset:64
    ds_read_b128 v[60:63], v10 offset:4672
    ds_read_b64_tr_b16 v[64:65], v12 offset:14336
    ds_read_b64_tr_b16 v[66:67], v12 offset:16128
    ds_read_b64_tr_b16 v[68:69], v12 offset:14400
    ds_read_b64_tr_b16 v[70:71], v12 offset:16192
    ds_read_b64_tr_b16 v[72:73], v12 offset:14464
    ds_read_b64_tr_b16 v[74:75], v12 offset:16256
    s_waitcnt lgkmcnt(8)
    v_mfma_f32_32x32x16_bf16 v[96:111], v[76:79], v[84:87], v[96:111]
    v_mfma_f32_32x32x16_bf16 v[112:127], v[76:79], v[88:91], v[112:127]
    v_mfma_f32_32x32x16_bf16 v[128:143], v[76:79], v[92:95], v[128:143]
    v_mfma_f32_32x32x16_bf16 v[144:159], v[80:83], v[84:87], v[144:159]
    v_mfma_f32_32x32x16_bf16 v[160:175], v[80:83], v[88:91], v[160:175]
    v_mfma_f32_32x32x16_bf16 v[176:191], v[80:83], v[92:95], v[176:191]
    ds_read_b128 v[76:79], v10 offset:96
    ds_read_b128 v[80:83], v10 offset:4704
    ds_read_b64_tr_b16 v[84:85], v12 offset:21504
    ds_read_b64_tr_b16 v[86:87], v12 offset:23296
    ds_read_b64_tr_b16 v[88:89], v12 offset:21568
    ds_read_b64_tr_b16 v[90:91], v12 offset:23360
    ds_read_b64_tr_b16 v[92:93], v12 offset:21632
    ds_read_b64_tr_b16 v[94:95], v12 offset:23424
    s_waitcnt lgkmcnt(8)
    v_mfma_f32_32x32x16_bf16 v[96:111], v[56:59], v[64:67], v[96:111]
    v_mfma_f32_32x32x16_bf16 v[112:127], v[56:59], v[68:71], v[112:127]
    v_mfma_f32_32x32x16_bf16 v[128:143], v[56:59], v[72:75], v[128:143]
    v_mfma_f32_32x32x16_bf16 v[144:159], v[60:63], v[64:67], v[144:159]
    v_mfma_f32_32x32x16_bf16 v[160:175], v[60:63], v[68:71], v[160:175]
    v_mfma_f32_32x32x16_bf16 v[176:191], v[60:63], v[72:75], v[176:191]
    s_waitcnt lgkmcnt(0)
    v_mfma_f32_32x32x16_bf16 v[96:111], v[76:79], v[84:87], v[96:111]
    v_mfma_f32_32x32x16_bf16 v[112:127], v[76:79], v[88:91], v[112:127]
    v_mfma_f32_32x32x16_bf16 v[128:143], v[76:79], v[92:95], v[128:143]
    v_mfma_f32_32x32x16_bf16 v[144:159], v[80:83], v[84:87], v[144:159]
    v_mfma_f32_32x32x16_bf16 v[160:175], v[80:83], v[88:91], v[160:175]
    v_mfma_f32_32x32x16_bf16 v[176:191], v[80:83], v[92:95], v[176:191]
    s_waitcnt vmcnt(0)
    ds_write_b128 v8, v[16:19] offset:47104
    ds_write_b128 v8, v[20:23] offset:51712
    ds_write_b128 v8, v[24:27] offset:56320
    ds_write_b128 v8, v[28:31] offset:60928
    ds_write_b128 v9, v[32:35] offset:47104
    ds_write_b128 v9, v[36:39] offset:47232
    ds_write_b128 v9, v[40:43] offset:47360
    ds_write_b128 v9, v[44:47] offset:61440
    ds_write_b128 v9, v[48:51] offset:61568
    ds_write_b128 v9, v[52:55] offset:61696
    s_waitcnt lgkmcnt(0)
    s_barrier
    s_add_u32 s21, s21, 128
    s_add_u32 s22, s22, s23
    buffer_load_dwordx4 v[16:19], v2, s[8:11], s21 offen
    buffer_load_dwordx4 v[20:23], v3, s[8:11], s21 offen
    buffer_load_dwordx4 v[24:27], v4, s[8:11], s21 offen
    buffer_load_dwordx4 v[28:31], v5, s[8:11], s21 offen
    buffer_load_dwordx4 v[32:35], v6, s[12:15], s22 offen offset:0
    buffer_load_dwordx4 v[36:39], v6, s[12:15], s22 offen offset:128
    buffer_load_dwordx4 v[40:43], v6, s[12:15], s22 offen offset:256
    buffer_load_dwordx4 v[44:47], v7, s[12:15], s22 offen offset:0
    buffer_load_dwordx4 v[48:51], v7, s[12:15], s22 offen offset:128
    buffer_load_dwordx4 v[52:55], v7, s[12:15], s22 offen offset:256
    ds_read_b128 v[56:59], v11 offset:0
    ds_read_b128 v[60:63], v11 offset:4608
    ds_read_b64_tr_b16 v[64:65], v13 offset:0
    ds_read_b64_tr_b16 v[66:67], v13 offset:1792
    ds_read_b64_tr_b16 v[68:69], v13 offset:64
    ds_read_b64_tr_b16 v[70:71], v13 offset:1856
    ds_read_b64_tr_b16 v[72:73], v13 offset:128
    ds_read_b64_tr_b16 v[74:75], v13 offset:1920
    ds_read_b128 v[76:79], v11 offset:32
    ds_read_b128 v[80:83], v11 offset:4640
    ds_read_b64_tr_b16 v[84:85], v13 offset:7168
    ds_read_b64_tr_b16 v[86:87], v13 offset:8960
    ds_read_b64_tr_b16 v[88:89], v13 offset:7232
    ds_read_b64_tr_b16 v[90:91], v13 offset:9024
    ds_read_b64_tr_b16 v[92:93], v13 offset:7296
    ds_read_b64_tr_b16 v[94:95], v13 offset:9088
    s_waitcnt lgkmcnt(8)
    v_mfma_f32_32x32x16_bf16 v[96:111], v[56:59], v[64:67], v[96:111]
    v_mfma_f32_32x32x16_bf16 v[112:127], v[56:59], v[68:71], v[112:127]
    v_mfma_f32_32x32x16_bf16 v[128:143], v[56:59], v[72:75], v[128:143]
    v_mfma_f32_32x32x16_bf16 v[144:159], v[60:63], v[64:67], v[144:159]
    v_mfma_f32_32x32x16_bf16 v[160:175], v[60:63], v[68:71], v[160:175]
    v_mfma_f32_32x32x16_bf16 v[176:191], v[60:63], v[72:75], v[176:191]
    ds_read_b128 v[56:59], v11 offset:64
    ds_read_b128 v[60:63], v11 offset:4672
    ds_read_b64_tr_b16 v[64:65], v13 offset:14336
    ds_read_b64_tr_b16 v[66:67], v13 offset:16128
    ds_read_b64_tr_b16 v[68:69], v13 offset:14400
    ds_read_b64_tr_b16 v[70:71], v13 offset:16192
    ds_read_b64_tr_b16 v[72:73], v13 offset:14464
    ds_read_b64_tr_b16 v[74:75], v13 offset:16256
    s_waitcnt lgkmcnt(8)
    v_mfma_f32_32x32x16_bf16 v[96:111], v[76:79], v[84:87], v[96:111]
    v_mfma_f32_32x32x16_bf16 v[112:127], v[76:79], v[88:91], v[112:127]
    v_mfma_f32_32x32x16_bf16 v[128:143], v[76:79], v[92:95], v[128:143]
    v_mfma_f32_32x32x16_bf16 v[144:159], v[80:83], v[84:87], v[144:159]
    v_mfma_f32_32x32x16_bf16 v[160:175], v[80:83], v[88:91], v[160:175]
    v_mfma_f32_32x32x16_bf16 v[176:191], v[80:83], v[92:95], v[176:191]
    ds_read_b128 v[76:79], v11 offset:96
    ds_read_b128 v[80:83], v11 offset:4704
    ds_read_b64_tr_b16 v[84:85], v13 offset:21504
    ds_read_b64_tr_b16 v[86:87], v13 offset:23296
    ds_read_b64_tr_b16 v[88:89], v13 offset:21568
    ds_read_b64_tr_b16 v[90:91], v13 offset:23360
    ds_read_b64_tr_b16 v[92:93], v13 offset:21632
    ds_read_b64_tr_b16 v[94:95], v13 offset:23424
    s_waitcnt lgkmcnt(8)
    v_mfma_f32_32x32x16_bf16 v[96:111], v[56:59], v[64:67], v[96:111]
    v_mfma_f32_32x32x16_bf16 v[112:127], v[56:59], v[68:71], v[112:127]
    v_mfma_f32_32x32x16_bf16 v[128:143], v[56:59], v[72:75], v[128:143]
    v_mfma_f32_32x32x16_bf16 v[144:159], v[60:63], v[64:67], v[144:159]
    v_mfma_f32_32x32x16_bf16 v[160:175], v[60:63], v[68:71], v[160:175]
    v_mfma_f32_32x32x16_bf16 v[176:191], v[60:63], v[72:75], v[176:191]
    s_waitcnt lgkmcnt(0)
    v_mfma_f32_32x32x16_bf16 v[96:111], v[76:79], v[84:87], v[96:111]
    v_mfma_f32_32x32x16_bf16 v[112:127], v[76:79], v[88:91], v[112:127]
    v_mfma_f32_32x32x16_bf16 v[128:143], v[76:79], v[92:95], v[128:143]
    v_mfma_f32_32x32x16_bf16 v[144:159], v[80:83], v[84:87], v[144:159]
    v_mfma_f32_32x32x16_bf16 v[160:175], v[80:83], v[88:91], v[160:175]
    v_mfma_f32_32x32x16_bf16 v[176:191], v[80:83], v[92:95], v[176:191]
    s_waitcnt vmcnt(0)
    ds_write_b128 v8, v[16:19] offset:0
    ds_write_b128 v8, v[20:23] offset:4608
    ds_write_b128 v8, v[24:27] offset:9216
    ds_write_b128 v8, v[28:31] offset:13824
    ds_write_b128 v9, v[32:35] offset:0
    ds_write_b128 v9, v[36:39] offset:128
    ds_write_b128 v9, v[40:43] offset:256
    ds_write_b128 v9, v[44:47] offset:14336
    ds_write_b128 v9, v[48:51] offset:14464
    ds_write_b128 v9, v[52:55] offset:14592
    s_waitcnt lgkmcnt(0)
    s_barrier
    s_add_u32 s24, s24, 1
    s_cmp_lt_u32 s24, 4
    s_cbranch_scc1 K1_LNNN
    s_nop 7
    s_nop 7
    v_lshlrev_b32 v14, 4, v1
    s_lshl_b32 s35, s3, 2
    s_lshl_b32 s36, s6, 1
    s_add_u32 s35, s35, s36
    s_add_u32 s35, s35, 0
    s_add_u32 s36, s25, 0
    s_sub_u32 s37, s36, 32
    s_lshl_b32 s37, s37, 17
    s_lshl_b32 s38, s35, 10
    s_add_u32 s37, s37, s38
    s_add_u32 s37, s37, 4194304
    v_bfe_u32 v15, v1, 4, 1
    v_lshlrev_b32 v15, 16, v15
    v_lshrrev_b32 v16, 5, v1
    v_lshl_add_u32 v15, v16, 8, v15
    v_and_b32 v16, 15, v1
    v_lshl_add_u32 v15, v16, 4, v15
    v_cvt_pk_bf16_f32 v200, v96, v97
    v_cvt_pk_bf16_f32 v201, v98, v99
    v_cvt_pk_bf16_f32 v202, v100, v101
    v_cvt_pk_bf16_f32 v203, v102, v103
    buffer_store_dwordx4 v[200:203], v15, s[16:19], s37 offen offset:0
    s_nop 1
    v_cvt_pk_bf16_f32 v200, v104, v105
    v_cvt_pk_bf16_f32 v201, v106, v107
    v_cvt_pk_bf16_f32 v202, v108, v109
    v_cvt_pk_bf16_f32 v203, v110, v111
    buffer_store_dwordx4 v[200:203], v15, s[16:19], s37 offen offset:512
    s_nop 1
    s_lshl_b32 s35, s3, 2
    s_lshl_b32 s36, s6, 1
    s_add_u32 s35, s35, s36
    s_add_u32 s35, s35, 0
    s_add_u32 s36, s25, 1
    s_sub_u32 s37, s36, 32
    s_lshl_b32 s37, s37, 17
    s_lshl_b32 s38, s35, 10
    s_add_u32 s37, s37, s38
    s_add_u32 s37, s37, 4194304
    v_bfe_u32 v15, v1, 4, 1
    v_lshlrev_b32 v15, 16, v15
    v_lshrrev_b32 v16, 5, v1
    v_lshl_add_u32 v15, v16, 8, v15
    v_and_b32 v16, 15, v1
    v_lshl_add_u32 v15, v16, 4, v15
    v_cvt_pk_bf16_f32 v200, v112, v113
    v_cvt_pk_bf16_f32 v201, v114, v115
    v_cvt_pk_bf16_f32 v202, v116, v117
    v_cvt_pk_bf16_f32 v203, v118, v119
    buffer_store_dwordx4 v[200:203], v15, s[16:19], s37 offen offset:0
    s_nop 1
    v_cvt_pk_bf16_f32 v200, v120, v121
    v_cvt_pk_bf16_f32 v201, v122, v123
    v_cvt_pk_bf16_f32 v202, v124, v125
    v_cvt_pk_bf16_f32 v203, v126, v127
    buffer_store_dwordx4 v[200:203], v15, s[16:19], s37 offen offset:512
    s_nop 1
    s_lshl_b32 s35, s3, 2
    s_lshl_b32 s36, s6, 1
    s_add_u32 s35, s35, s36
    s_add_u32 s35, s35, 0
    s_add_u32 s36, s25, 2
    s_sub_u32 s37, s36, 32
    s_lshl_b32 s37, s37, 17
    s_lshl_b32 s38, s35, 10
    s_add_u32 s37, s37, s38
    s_add_u32 s37, s37, 4194304
    v_bfe_u32 v15, v1, 4, 1
    v_lshlrev_b32 v15, 16, v15
    v_lshrrev_b32 v16, 5, v1
    v_lshl_add_u32 v15, v16, 8, v15
    v_and_b32 v16, 15, v1
    v_lshl_add_u32 v15, v16, 4, v15
    v_cvt_pk_bf16_f32 v200, v128, v129
    v_cvt_pk_bf16_f32 v201, v130, v131
    v_cvt_pk_bf16_f32 v202, v132, v133
    v_cvt_pk_bf16_f32 v203, v134, v135
    buffer_store_dwordx4 v[200:203], v15, s[16:19], s37 offen offset:0
    s_nop 1
    v_cvt_pk_bf16_f32 v200, v136, v137
    v_cvt_pk_bf16_f32 v201, v138, v139
    v_cvt_pk_bf16_f32 v202, v140, v141
    v_cvt_pk_bf16_f32 v203, v142, v143
    buffer_store_dwordx4 v[200:203], v15, s[16:19], s37 offen offset:512
    s_nop 1
    s_lshl_b32 s35, s3, 2
    s_lshl_b32 s36, s6, 1
    s_add_u32 s35, s35, s36
    s_add_u32 s35, s35, 1
    s_add_u32 s36, s25, 0
    s_sub_u32 s37, s36, 32
    s_lshl_b32 s37, s37, 17
    s_lshl_b32 s38, s35, 10
    s_add_u32 s37, s37, s38
    s_add_u32 s37, s37, 4194304
    v_bfe_u32 v15, v1, 4, 1
    v_lshlrev_b32 v15, 16, v15
    v_lshrrev_b32 v16, 5, v1
    v_lshl_add_u32 v15, v16, 8, v15
    v_and_b32 v16, 15, v1
    v_lshl_add_u32 v15, v16, 4, v15
    v_cvt_pk_bf16_f32 v200, v144, v145
    v_cvt_pk_bf16_f32 v201, v146, v147
    v_cvt_pk_bf16_f32 v202, v148, v149
    v_cvt_pk_bf16_f32 v203, v150, v151
    buffer_store_dwordx4 v[200:203], v15, s[16:19], s37 offen offset:0
    s_nop 1
    v_cvt_pk_bf16_f32 v200, v152, v153
    v_cvt_pk_bf16_f32 v201, v154, v155
    v_cvt_pk_bf16_f32 v202, v156, v157
    v_cvt_pk_bf16_f32 v203, v158, v159
    buffer_store_dwordx4 v[200:203], v15, s[16:19], s37 offen offset:512
    s_nop 1
    s_lshl_b32 s35, s3, 2
    s_lshl_b32 s36, s6, 1
    s_add_u32 s35, s35, s36
    s_add_u32 s35, s35, 1
    s_add_u32 s36, s25, 1
    s_sub_u32 s37, s36, 32
    s_lshl_b32 s37, s37, 17
    s_lshl_b32 s38, s35, 10
    s_add_u32 s37, s37, s38
    s_add_u32 s37, s37, 4194304
    v_bfe_u32 v15, v1, 4, 1
    v_lshlrev_b32 v15, 16, v15
    v_lshrrev_b32 v16, 5, v1
    v_lshl_add_u32 v15, v16, 8, v15
    v_and_b32 v16, 15, v1
    v_lshl_add_u32 v15, v16, 4, v15
    v_cvt_pk_bf16_f32 v200, v160, v161
    v_cvt_pk_bf16_f32 v201, v162, v163
    v_cvt_pk_bf16_f32 v202, v164, v165
    v_cvt_pk_bf16_f32 v203, v166, v167
    buffer_store_dwordx4 v[200:203], v15, s[16:19], s37 offen offset:0
    s_nop 1
    v_cvt_pk_bf16_f32 v200, v168, v169
    v_cvt_pk_bf16_f32 v201, v170, v171
    v_cvt_pk_bf16_f32 v202, v172, v173
    v_cvt_pk_bf16_f32 v203, v174, v175
    buffer_store_dwordx4 v[200:203], v15, s[16:19], s37 offen offset:512
    s_nop 1
    s_lshl_b32 s35, s3, 2
    s_lshl_b32 s36, s6, 1
    s_add_u32 s35, s35, s36
    s_add_u32 s35, s35, 1
    s_add_u32 s36, s25, 2
    s_sub_u32 s37, s36, 32
    s_lshl_b32 s37, s37, 17
    s_lshl_b32 s38, s35, 10
    s_add_u32 s37, s37, s38
    s_add_u32 s37, s37, 4194304
    v_bfe_u32 v15, v1, 4, 1
    v_lshlrev_b32 v15, 16, v15
    v_lshrrev_b32 v16, 5, v1
    v_lshl_add_u32 v15, v16, 8, v15
    v_and_b32 v16, 15, v1
    v_lshl_add_u32 v15, v16, 4, v15
    v_cvt_pk_bf16_f32 v200, v176, v177
    v_cvt_pk_bf16_f32 v201, v178, v179
    v_cvt_pk_bf16_f32 v202, v180, v181
    v_cvt_pk_bf16_f32 v203, v182, v183
    buffer_store_dwordx4 v[200:203], v15, s[16:19], s37 offen offset:0
    s_nop 1
    v_cvt_pk_bf16_f32 v200, v184, v185
    v_cvt_pk_bf16_f32 v201, v186, v187
    v_cvt_pk_bf16_f32 v202, v188, v189
    v_cvt_pk_bf16_f32 v203, v190, v191
    buffer_store_dwordx4 v[200:203], v15, s[16:19], s37 offen offset:512
    s_nop 1
    s_branch K1_END
K1_END:
    s_endpgm
.p2align 8
.type attn_kernel,@function
attn_kernel:
    s_cmp_ge_u32 s2, 256
    s_cbranch_scc1 K2_END
    s_load_dwordx2 s[26:27], s[0:1], 0
    s_load_dwordx2 s[28:29], s[0:1], 48
    s_load_dwordx2 s[32:33], s[0:1], 72
    s_and_b32 s3, s2, 31
    s_lshr_b32 s4, s2, 5
    v_lshrrev_b32 v2, 6, v0
    v_and_b32 v1, 63, v0
    v_readfirstlane_b32 s5, v2
    v_lshlrev_b32 v3, 4, v1
    s_waitcnt lgkmcnt(0)
    s_mov_b32 s8, s26
    s_and_b32 s9, s27, 0xffff
    s_mov_b32 s10, 2097152
    s_mov_b32 s11, 0x00020000
    s_mov_b32 s12, s28
    s_and_b32 s13, s29, 0xffff
    s_mov_b32 s14, 1024
    s_mov_b32 s15, 0x00020000
    s_mov_b32 s16, s32
    s_and_b32 s17, s33, 0xffff
    s_mov_b32 s18, 16777216
    s_mov_b32 s19, 0x00020000
    s_lshl_b32 s21, s4, 3
    s_add_u32 s21, s21, s5
    s_lshl_b32 s22, s3, 6
    s_add_u32 s22, s22, s21
    s_lshl_b32 s22, s22, 10
    buffer_load_dwordx4 v[4:7], v3, s[16:19], s22 offen
    s_lshl_b32 s6, s3, 16
    s_lshl_b32 s7, s5, 10
    s_add_u32 s20, s6, 2097152
    s_add_u32 s20, s20, s7
    s_add_u32 s23, s6, 4194304
    s_add_u32 s23, s23, s7
    s_add_u32 s24, s7, 0x10000
    s_mov_b32 m0, s7
    s_nop 0
    buffer_load_dwordx4 v3, s[16:19], s20 offen lds
    s_mov_b32 m0, s24
    s_nop 0
    buffer_load_dwordx4 v3, s[16:19], s23 offen lds
    s_add_u32 s7, s7, 8192
    s_add_u32 s24, s24, 8192
    s_add_u32 s20, s20, 8192
    s_add_u32 s23, s23, 8192
    s_mov_b32 m0, s7
    s_nop 0
    buffer_load_dwordx4 v3, s[16:19], s20 offen lds
    s_mov_b32 m0, s24
    s_nop 0
    buffer_load_dwordx4 v3, s[16:19], s23 offen lds
    s_add_u32 s7, s7, 8192
    s_add_u32 s24, s24, 8192
    s_add_u32 s20, s20, 8192
    s_add_u32 s23, s23, 8192
    s_mov_b32 m0, s7
    s_nop 0
    buffer_load_dwordx4 v3, s[16:19], s20 offen lds
    s_mov_b32 m0, s24
    s_nop 0
    buffer_load_dwordx4 v3, s[16:19], s23 offen lds
    s_add_u32 s7, s7, 8192
    s_add_u32 s24, s24, 8192
    s_add_u32 s20, s20, 8192
    s_add_u32 s23, s23, 8192
    s_mov_b32 m0, s7
    s_nop 0
    buffer_load_dwordx4 v3, s[16:19], s20 offen lds
    s_mov_b32 m0, s24
    s_nop 0
    buffer_load_dwordx4 v3, s[16:19], s23 offen lds
    s_add_u32 s7, s7, 8192
    s_add_u32 s24, s24, 8192
    s_add_u32 s20, s20, 8192
    s_add_u32 s23, s23, 8192
    s_mov_b32 m0, s7
    s_nop 0
    buffer_load_dwordx4 v3, s[16:19], s20 offen lds
    s_mov_b32 m0, s24
    s_nop 0
    buffer_load_dwordx4 v3, s[16:19], s23 offen lds
    s_add_u32 s7, s7, 8192
    s_add_u32 s24, s24, 8192
    s_add_u32 s20, s20, 8192
    s_add_u32 s23, s23, 8192
    s_mov_b32 m0, s7
    s_nop 0
    buffer_load_dwordx4 v3, s[16:19], s20 offen lds
    s_mov_b32 m0, s24
    s_nop 0
    buffer_load_dwordx4 v3, s[16:19], s23 offen lds
    s_add_u32 s7, s7, 8192
    s_add_u32 s24, s24, 8192
    s_add_u32 s20, s20, 8192
    s_add_u32 s23, s23, 8192
    s_mov_b32 m0, s7
    s_nop 0
    buffer_load_dwordx4 v3, s[16:19], s20 offen lds
    s_mov_b32 m0, s24
    s_nop 0
    buffer_load_dwordx4 v3, s[16:19], s23 offen lds
    s_add_u32 s7, s7, 8192
    s_add_u32 s24, s24, 8192
    s_add_u32 s20, s20, 8192
    s_add_u32 s23, s23, 8192
    s_mov_b32 m0, s7
    s_nop 0
    buffer_load_dwordx4 v3, s[16:19], s20 offen lds
    s_mov_b32 m0, s24
    s_nop 0
    buffer_load_dwordx4 v3, s[16:19], s23 offen lds
    s_lshl_b32 s23, s4, 8
    s_lshl_b32 s24, s3, 3
    s_add_u32 s23, s23, s24
    s_add_u32 s23, s23, s5
    s_lshl_b32 s24, s23, 10
    buffer_load_dwordx4 v[24:27], v3, s[8:11], s24 offen
    buffer_load_dwordx4 v[28:31], v3, s[12:15], 0 offen
    v_and_b32 v2, 31, v1
    v_cmp_eq_u32 vcc, 16, v2
    v_mov_b32 v104, 0x3f803f80
    s_nop 1
    v_cndmask_b32 v2, 0, v104, vcc
    v_mov_b32 v80, 0
    v_mov_b32 v64, 0
    v_mov_b32 v81, 0
    v_mov_b32 v65, 0
    v_mov_b32 v82, 0
    v_mov_b32 v66, 0
    v_mov_b32 v83, 0
    v_mov_b32 v67, 0
    v_mov_b32 v84, 0
    v_mov_b32 v68, 0
    v_mov_b32 v85, 0
    v_mov_b32 v69, 0
    v_mov_b32 v86, 0
    v_mov_b32 v70, 0
    v_mov_b32 v87, 0
    v_mov_b32 v71, 0
    v_mov_b32 v88, 0
    v_mov_b32 v72, 0
    v_mov_b32 v89, 0
    v_mov_b32 v73, 0
    v_mov_b32 v90, 0
    v_mov_b32 v74, 0
    v_mov_b32 v91, 0
    v_mov_b32 v75, 0
    v_mov_b32 v92, 0
    v_mov_b32 v76, 0
    v_mov_b32 v93, 0
    v_mov_b32 v77, 0
    v_mov_b32 v94, 0
    v_mov_b32 v78, 0
    v_mov_b32 v95, 0
    v_mov_b32 v79, 0
    v_mov_b32 v107, v2
    s_waitcnt vmcnt(0)
    v_mov_b32 v12, 0
    v_lshlrev_b32 v13, 16, v24
    v_lshlrev_b32 v14, 16, v28
    v_mul_f32 v13, v13, v14
    v_and_b32 v14, 0xffff0000, v24
    v_and_b32 v15, 0xffff0000, v28
    v_mul_f32 v14, v14, v15
    v_cvt_pk_bf16_f32 v13, v13, v14
    v_lshlrev_b32 v14, 16, v13
    v_add_f32 v12, v12, v14
    v_and_b32 v14, 0xffff0000, v13
    v_add_f32 v12, v12, v14
    v_lshlrev_b32 v13, 16, v25
    v_lshlrev_b32 v14, 16, v29
    v_mul_f32 v13, v13, v14
    v_and_b32 v14, 0xffff0000, v25
    v_and_b32 v15, 0xffff0000, v29
    v_mul_f32 v14, v14, v15
    v_cvt_pk_bf16_f32 v13, v13, v14
    v_lshlrev_b32 v14, 16, v13
    v_add_f32 v12, v12, v14
    v_and_b32 v14, 0xffff0000, v13
    v_add_f32 v12, v12, v14
    v_lshlrev_b32 v13, 16, v26
    v_lshlrev_b32 v14, 16, v30
    v_mul_f32 v13, v13, v14
    v_and_b32 v14, 0xffff0000, v26
    v_and_b32 v15, 0xffff0000, v30
    v_mul_f32 v14, v14, v15
    v_cvt_pk_bf16_f32 v13, v13, v14
    v_lshlrev_b32 v14, 16, v13
    v_add_f32 v12, v12, v14
    v_and_b32 v14, 0xffff0000, v13
    v_add_f32 v12, v12, v14
    v_lshlrev_b32 v13, 16, v27
    v_lshlrev_b32 v14, 16, v31
    v_mul_f32 v13, v13, v14
    v_and_b32 v14, 0xffff0000, v27
    v_and_b32 v15, 0xffff0000, v31
    v_mul_f32 v14, v14, v15
    v_cvt_pk_bf16_f32 v13, v13, v14
    v_lshlrev_b32 v14, 16, v13
    v_add_f32 v12, v12, v14
    v_and_b32 v14, 0xffff0000, v13
    v_add_f32 v12, v12, v14
    ds_swizzle_b32 v13, v12 offset:1055
    s_waitcnt lgkmcnt(0)
    v_add_f32 v12, v12, v13
    ds_swizzle_b32 v13, v12 offset:2079
    s_waitcnt lgkmcnt(0)
    v_add_f32 v12, v12, v13
    ds_swizzle_b32 v13, v12 offset:4127
    s_waitcnt lgkmcnt(0)
    v_add_f32 v12, v12, v13
    ds_swizzle_b32 v13, v12 offset:8223
    s_waitcnt lgkmcnt(0)
    v_add_f32 v12, v12, v13
    ds_swizzle_b32 v13, v12 offset:16415
    s_waitcnt lgkmcnt(0)
    v_add_f32 v12, v12, v13
    v_mov_b32 v13, v12
    s_nop 1
    v_permlane32_swap_b32 v12, v13
    v_add_f32 v12, v12, v13
    v_cvt_pk_bf16_f32 v12, v12, v12
    v_lshlrev_b32 v12, 16, v12
    v_mul_f32 v12, 3216550459, v12
    v_exp_f32 v12, v12
    s_nop 0
    v_add_f32 v12, 1.0, v12
    v_rcp_f32 v12, v12
    s_nop 0
    v_cvt_pk_bf16_f32 v12, v12, v12
    v_lshlrev_b32 v12, 16, v12
    s_lshl_b32 s24, s23, 2
    s_add_u32 s24, s24, 14680064
    v_cmp_eq_u32 vcc, 0, v1
    s_and_saveexec_b64 s[30:31], vcc
    v_mov_b32 v13, 0
    buffer_store_dword v12, v13, s[16:19], s24 offen
    s_mov_b64 exec, s[30:31]
    v_mov_b32 v16, v107
    v_mov_b32 v17, v107
    v_mov_b32 v18, v107
    v_mov_b32 v19, v107
    v_mov_b32 v20, v107
    v_mov_b32 v21, v107
    v_mov_b32 v22, v107
    v_mov_b32 v23, v107
    v_mov_b32 v24, v107
    v_mov_b32 v25, v107
    v_mov_b32 v26, v107
    v_mov_b32 v27, v107
    v_mov_b32 v28, v107
    v_mov_b32 v29, v107
    v_mov_b32 v30, v107
    v_mov_b32 v31, v107
    v_lshlrev_b32 v2, 4, v1
    v_lshrrev_b32 v3, 5, v1
    v_and_b32 v12, 15, v1
    v_lshlrev_b32 v12, 4, v12
    v_lshl_add_u32 v3, v3, 8, v12
    v_add_u32 v3, 0x10000, v3
    s_mov_b32 s34, 0xffff
    s_mov_b32 s35, 0xffff
    s_mov_b32 s36, 1090519040
    s_barrier
    ds_read_b128 v[8:11], v2
    s_mov_b64 exec, s[34:35]
    ds_read_b128 v[16:19], v3
    ds_read_b128 v[20:23], v3 offset:512
    s_mov_b64 exec, -1
    ds_read_b128 v[12:15], v2 offset:1024
    s_waitcnt lgkmcnt(3)
    v_mfma_f32_32x32x16_bf16 v[32:47], v[8:11], v[4:7], v[64:79]
    s_mov_b64 exec, s[34:35]
    ds_read_b128 v[24:27], v3 offset:1024
    ds_read_b128 v[28:31], v3 offset:1536
    s_mov_b64 exec, -1
    s_waitcnt lgkmcnt(2)
    v_mfma_f32_32x32x16_bf16 v[48:63], v[12:15], v[4:7], v[64:79]
    ds_read_b128 v[8:11], v2 offset:2048
    s_nop 7
    s_nop 3
    v_max3_f32 v104, v32, v33, v34
    v_max3_f32 v104, v104, v35, v36
    v_max3_f32 v104, v104, v37, v38
    v_max3_f32 v104, v104, v39, v40
    v_max3_f32 v104, v104, v41, v42
    v_max3_f32 v104, v104, v43, v44
    v_max3_f32 v104, v104, v45, v46
    v_max_f32 v104, v104, v47
    v_mov_b32 v105, v104
    s_nop 1
    v_permlane32_swap_b32 v104, v105
    v_max_f32 v104, v104, v105
    v_sub_f32 v105, 0, v104
    v_exp_f32 v105, v105
    v_sub_f32 v106, v64, v104
    v_mul_f32 v80, v80, v105
    v_mul_f32 v81, v81, v105
    v_mul_f32 v82, v82, v105
    v_mul_f32 v83, v83, v105
    v_mul_f32 v84, v84, v105
    v_mul_f32 v85, v85, v105
    v_mul_f32 v86, v86, v105
    v_mul_f32 v87, v87, v105
    v_mul_f32 v88, v88, v105
    v_mul_f32 v89, v89, v105
    v_mul_f32 v90, v90, v105
    v_mul_f32 v91, v91, v105
    v_mul_f32 v92, v92, v105
    v_mul_f32 v93, v93, v105
    v_mul_f32 v94, v94, v105
    v_mul_f32 v95, v95, v105
    v_mov_b32 v64, v106
    v_mov_b32 v65, v106
    v_mov_b32 v66, v106
    v_mov_b32 v67, v106
    v_mov_b32 v68, v106
    v_mov_b32 v69, v106
    v_mov_b32 v70, v106
    v_mov_b32 v71, v106
    v_mov_b32 v72, v106
    v_mov_b32 v73, v106
    v_mov_b32 v74, v106
    v_mov_b32 v75, v106
    v_mov_b32 v76, v106
    v_mov_b32 v77, v106
    v_mov_b32 v78, v106
    v_mov_b32 v79, v106
    v_sub_f32 v32, v32, v104
    v_sub_f32 v33, v33, v104
    v_sub_f32 v34, v34, v104
    v_sub_f32 v35, v35, v104
    v_sub_f32 v36, v36, v104
    v_sub_f32 v37, v37, v104
    v_sub_f32 v38, v38, v104
    v_sub_f32 v39, v39, v104
    v_sub_f32 v40, v40, v104
    v_sub_f32 v41, v41, v104
    v_sub_f32 v42, v42, v104
    v_sub_f32 v43, v43, v104
    v_sub_f32 v44, v44, v104
    v_sub_f32 v45, v45, v104
    v_sub_f32 v46, v46, v104
    v_sub_f32 v47, v47, v104
    v_sub_f32 v48, v48, v104
    v_sub_f32 v49, v49, v104
    v_sub_f32 v50, v50, v104
    v_sub_f32 v51, v51, v104
    v_sub_f32 v52, v52, v104
    v_sub_f32 v53, v53, v104
    v_sub_f32 v54, v54, v104
    v_sub_f32 v55, v55, v104
    v_sub_f32 v56, v56, v104
    v_sub_f32 v57, v57, v104
    v_sub_f32 v58, v58, v104
    v_sub_f32 v59, v59, v104
    v_sub_f32 v60, v60, v104
    v_sub_f32 v61, v61, v104
    v_sub_f32 v62, v62, v104
    v_sub_f32 v63, v63, v104
    v_exp_f32 v32, v32
    v_exp_f32 v33, v33
    v_exp_f32 v34, v34
    v_exp_f32 v35, v35
    v_exp_f32 v36, v36
    v_exp_f32 v37, v37
    v_exp_f32 v38, v38
    v_exp_f32 v39, v39
    v_exp_f32 v40, v40
    v_exp_f32 v41, v41
    v_exp_f32 v42, v42
    v_exp_f32 v43, v43
    v_exp_f32 v44, v44
    v_exp_f32 v45, v45
    v_exp_f32 v46, v46
    v_exp_f32 v47, v47
    s_nop 0
    v_cvt_pk_bf16_f32 v96, v32, v33
    v_cvt_pk_bf16_f32 v97, v34, v35
    v_cvt_pk_bf16_f32 v98, v36, v37
    v_cvt_pk_bf16_f32 v99, v38, v39
    v_cvt_pk_bf16_f32 v100, v40, v41
    v_cvt_pk_bf16_f32 v101, v42, v43
    v_cvt_pk_bf16_f32 v102, v44, v45
    v_cvt_pk_bf16_f32 v103, v46, v47
    s_nop 1
    v_mfma_f32_32x32x16_bf16 v[80:95], v[16:19], v[96:99], v[80:95]
    v_mfma_f32_32x32x16_bf16 v[80:95], v[20:23], v[100:103], v[80:95]
    s_mov_b32 s37, 0
K2_LOOP:
    s_mov_b64 exec, s[34:35]
    ds_read_b128 v[16:19], v3 offset:2048
    ds_read_b128 v[20:23], v3 offset:2560
    s_mov_b64 exec, -1
    s_waitcnt lgkmcnt(2)
    v_mfma_f32_32x32x16_bf16 v[32:47], v[8:11], v[4:7], v[64:79]
    ds_read_b128 v[12:15], v2 offset:3072
    v_max3_f32 v104, v48, v49, v50
    v_max3_f32 v104, v104, v51, v52
    v_max3_f32 v104, v104, v53, v54
    v_max3_f32 v104, v104, v55, v56
    v_max3_f32 v104, v104, v57, v58
    v_max3_f32 v104, v104, v59, v60
    v_max3_f32 v104, v104, v61, v62
    v_max_f32 v104, v104, v63
    v_mov_b32 v105, v104
    s_nop 1
    v_permlane32_swap_b32 v104, v105
    v_max_f32 v104, v104, v105
    v_cmp_lt_f32 vcc, s36, v104
    s_nop 1
    s_cbranch_vccz K2_FAST1
    v_max_f32 v104, 0, v104
    s_nop 15
    v_sub_f32 v105, 0, v104
    v_exp_f32 v105, v105
    v_sub_f32 v106, v64, v104
    v_mul_f32 v80, v80, v105
    v_mul_f32 v81, v81, v105
    v_mul_f32 v82, v82, v105
    v_mul_f32 v83, v83, v105
    v_mul_f32 v84, v84, v105
    v_mul_f32 v85, v85, v105
    v_mul_f32 v86, v86, v105
    v_mul_f32 v87, v87, v105
    v_mul_f32 v88, v88, v105
    v_mul_f32 v89, v89, v105
    v_mul_f32 v90, v90, v105
    v_mul_f32 v91, v91, v105
    v_mul_f32 v92, v92, v105
    v_mul_f32 v93, v93, v105
    v_mul_f32 v94, v94, v105
    v_mul_f32 v95, v95, v105
    v_mov_b32 v64, v106
    v_mov_b32 v65, v106
    v_mov_b32 v66, v106
    v_mov_b32 v67, v106
    v_mov_b32 v68, v106
    v_mov_b32 v69, v106
    v_mov_b32 v70, v106
    v_mov_b32 v71, v106
    v_mov_b32 v72, v106
    v_mov_b32 v73, v106
    v_mov_b32 v74, v106
    v_mov_b32 v75, v106
    v_mov_b32 v76, v106
    v_mov_b32 v77, v106
    v_mov_b32 v78, v106
    v_mov_b32 v79, v106
    v_sub_f32 v48, v48, v104
    v_sub_f32 v49, v49, v104
    v_sub_f32 v50, v50, v104
    v_sub_f32 v51, v51, v104
    v_sub_f32 v52, v52, v104
    v_sub_f32 v53, v53, v104
    v_sub_f32 v54, v54, v104
    v_sub_f32 v55, v55, v104
    v_sub_f32 v56, v56, v104
    v_sub_f32 v57, v57, v104
    v_sub_f32 v58, v58, v104
    v_sub_f32 v59, v59, v104
    v_sub_f32 v60, v60, v104
    v_sub_f32 v61, v61, v104
    v_sub_f32 v62, v62, v104
    v_sub_f32 v63, v63, v104
    v_sub_f32 v32, v32, v104
    v_sub_f32 v33, v33, v104
    v_sub_f32 v34, v34, v104
    v_sub_f32 v35, v35, v104
    v_sub_f32 v36, v36, v104
    v_sub_f32 v37, v37, v104
    v_sub_f32 v38, v38, v104
    v_sub_f32 v39, v39, v104
    v_sub_f32 v40, v40, v104
    v_sub_f32 v41, v41, v104
    v_sub_f32 v42, v42, v104
    v_sub_f32 v43, v43, v104
    v_sub_f32 v44, v44, v104
    v_sub_f32 v45, v45, v104
    v_sub_f32 v46, v46, v104
    v_sub_f32 v47, v47, v104
K2_FAST1:
    v_exp_f32 v48, v48
    v_exp_f32 v49, v49
    v_exp_f32 v50, v50
    v_exp_f32 v51, v51
    v_exp_f32 v52, v52
    v_exp_f32 v53, v53
    v_exp_f32 v54, v54
    v_exp_f32 v55, v55
    v_exp_f32 v56, v56
    v_exp_f32 v57, v57
    v_exp_f32 v58, v58
    v_exp_f32 v59, v59
    v_exp_f32 v60, v60
    v_exp_f32 v61, v61
    v_exp_f32 v62, v62
    v_exp_f32 v63, v63
    s_nop 0
    v_cvt_pk_bf16_f32 v96, v48, v49
    v_cvt_pk_bf16_f32 v97, v50, v51
    v_cvt_pk_bf16_f32 v98, v52, v53
    v_cvt_pk_bf16_f32 v99, v54, v55
    v_cvt_pk_bf16_f32 v100, v56, v57
    v_cvt_pk_bf16_f32 v101, v58, v59
    v_cvt_pk_bf16_f32 v102, v60, v61
    v_cvt_pk_bf16_f32 v103, v62, v63
    s_nop 1
    v_mfma_f32_32x32x16_bf16 v[80:95], v[24:27], v[96:99], v[80:95]
    v_mfma_f32_32x32x16_bf16 v[80:95], v[28:31], v[100:103], v[80:95]
    s_mov_b64 exec, s[34:35]
    ds_read_b128 v[24:27], v3 offset:3072
    ds_read_b128 v[28:31], v3 offset:3584
    s_mov_b64 exec, -1
    s_waitcnt lgkmcnt(2)
    v_mfma_f32_32x32x16_bf16 v[48:63], v[12:15], v[4:7], v[64:79]
    ds_read_b128 v[8:11], v2 offset:4096
    v_max3_f32 v104, v32, v33, v34
    v_max3_f32 v104, v104, v35, v36
    v_max3_f32 v104, v104, v37, v38
    v_max3_f32 v104, v104, v39, v40
    v_max3_f32 v104, v104, v41, v42
    v_max3_f32 v104, v104, v43, v44
    v_max3_f32 v104, v104, v45, v46
    v_max_f32 v104, v104, v47
    v_mov_b32 v105, v104
    s_nop 1
    v_permlane32_swap_b32 v104, v105
    v_max_f32 v104, v104, v105
    v_cmp_lt_f32 vcc, s36, v104
    s_nop 1
    s_cbranch_vccz K2_FAST2
    v_max_f32 v104, 0, v104
    s_nop 15
    v_sub_f32 v105, 0, v104
    v_exp_f32 v105, v105
    v_sub_f32 v106, v64, v104
    v_mul_f32 v80, v80, v105
    v_mul_f32 v81, v81, v105
    v_mul_f32 v82, v82, v105
    v_mul_f32 v83, v83, v105
    v_mul_f32 v84, v84, v105
    v_mul_f32 v85, v85, v105
    v_mul_f32 v86, v86, v105
    v_mul_f32 v87, v87, v105
    v_mul_f32 v88, v88, v105
    v_mul_f32 v89, v89, v105
    v_mul_f32 v90, v90, v105
    v_mul_f32 v91, v91, v105
    v_mul_f32 v92, v92, v105
    v_mul_f32 v93, v93, v105
    v_mul_f32 v94, v94, v105
    v_mul_f32 v95, v95, v105
    v_mov_b32 v64, v106
    v_mov_b32 v65, v106
    v_mov_b32 v66, v106
    v_mov_b32 v67, v106
    v_mov_b32 v68, v106
    v_mov_b32 v69, v106
    v_mov_b32 v70, v106
    v_mov_b32 v71, v106
    v_mov_b32 v72, v106
    v_mov_b32 v73, v106
    v_mov_b32 v74, v106
    v_mov_b32 v75, v106
    v_mov_b32 v76, v106
    v_mov_b32 v77, v106
    v_mov_b32 v78, v106
    v_mov_b32 v79, v106
    v_sub_f32 v32, v32, v104
    v_sub_f32 v33, v33, v104
    v_sub_f32 v34, v34, v104
    v_sub_f32 v35, v35, v104
    v_sub_f32 v36, v36, v104
    v_sub_f32 v37, v37, v104
    v_sub_f32 v38, v38, v104
    v_sub_f32 v39, v39, v104
    v_sub_f32 v40, v40, v104
    v_sub_f32 v41, v41, v104
    v_sub_f32 v42, v42, v104
    v_sub_f32 v43, v43, v104
    v_sub_f32 v44, v44, v104
    v_sub_f32 v45, v45, v104
    v_sub_f32 v46, v46, v104
    v_sub_f32 v47, v47, v104
    v_sub_f32 v48, v48, v104
    v_sub_f32 v49, v49, v104
    v_sub_f32 v50, v50, v104
    v_sub_f32 v51, v51, v104
    v_sub_f32 v52, v52, v104
    v_sub_f32 v53, v53, v104
    v_sub_f32 v54, v54, v104
    v_sub_f32 v55, v55, v104
    v_sub_f32 v56, v56, v104
    v_sub_f32 v57, v57, v104
    v_sub_f32 v58, v58, v104
    v_sub_f32 v59, v59, v104
    v_sub_f32 v60, v60, v104
    v_sub_f32 v61, v61, v104
    v_sub_f32 v62, v62, v104
    v_sub_f32 v63, v63, v104
K2_FAST2:
    v_exp_f32 v32, v32
    v_exp_f32 v33, v33
    v_exp_f32 v34, v34
    v_exp_f32 v35, v35
    v_exp_f32 v36, v36
    v_exp_f32 v37, v37
    v_exp_f32 v38, v38
    v_exp_f32 v39, v39
    v_exp_f32 v40, v40
    v_exp_f32 v41, v41
    v_exp_f32 v42, v42
    v_exp_f32 v43, v43
    v_exp_f32 v44, v44
    v_exp_f32 v45, v45
    v_exp_f32 v46, v46
    v_exp_f32 v47, v47
    s_nop 0
    v_cvt_pk_bf16_f32 v96, v32, v33
    v_cvt_pk_bf16_f32 v97, v34, v35
    v_cvt_pk_bf16_f32 v98, v36, v37
    v_cvt_pk_bf16_f32 v99, v38, v39
    v_cvt_pk_bf16_f32 v100, v40, v41
    v_cvt_pk_bf16_f32 v101, v42, v43
    v_cvt_pk_bf16_f32 v102, v44, v45
    v_cvt_pk_bf16_f32 v103, v46, v47
    s_nop 1
    v_mfma_f32_32x32x16_bf16 v[80:95], v[16:19], v[96:99], v[80:95]
    v_mfma_f32_32x32x16_bf16 v[80:95], v[20:23], v[100:103], v[80:95]
    v_add_u32 v2, 2048, v2
    v_add_u32 v3, 2048, v3
    s_add_u32 s37, s37, 1
    s_cmp_lt_u32 s37, 31
    s_cbranch_scc1 K2_LOOP
    s_mov_b64 exec, s[34:35]
    ds_read_b128 v[16:19], v3 offset:2048
    ds_read_b128 v[20:23], v3 offset:2560
    s_mov_b64 exec, -1
    s_waitcnt lgkmcnt(2)
    v_mfma_f32_32x32x16_bf16 v[32:47], v[8:11], v[4:7], v[64:79]
    ds_read_b128 v[12:15], v2 offset:3072
    v_max3_f32 v104, v48, v49, v50
    v_max3_f32 v104, v104, v51, v52
    v_max3_f32 v104, v104, v53, v54
    v_max3_f32 v104, v104, v55, v56
    v_max3_f32 v104, v104, v57, v58
    v_max3_f32 v104, v104, v59, v60
    v_max3_f32 v104, v104, v61, v62
    v_max_f32 v104, v104, v63
    v_mov_b32 v105, v104
    s_nop 1
    v_permlane32_swap_b32 v104, v105
    v_max_f32 v104, v104, v105
    v_cmp_lt_f32 vcc, s36, v104
    s_nop 1
    s_cbranch_vccz K2_FAST3
    v_max_f32 v104, 0, v104
    s_nop 15
    v_sub_f32 v105, 0, v104
    v_exp_f32 v105, v105
    v_sub_f32 v106, v64, v104
    v_mul_f32 v80, v80, v105
    v_mul_f32 v81, v81, v105
    v_mul_f32 v82, v82, v105
    v_mul_f32 v83, v83, v105
    v_mul_f32 v84, v84, v105
    v_mul_f32 v85, v85, v105
    v_mul_f32 v86, v86, v105
    v_mul_f32 v87, v87, v105
    v_mul_f32 v88, v88, v105
    v_mul_f32 v89, v89, v105
    v_mul_f32 v90, v90, v105
    v_mul_f32 v91, v91, v105
    v_mul_f32 v92, v92, v105
    v_mul_f32 v93, v93, v105
    v_mul_f32 v94, v94, v105
    v_mul_f32 v95, v95, v105
    v_mov_b32 v64, v106
    v_mov_b32 v65, v106
    v_mov_b32 v66, v106
    v_mov_b32 v67, v106
    v_mov_b32 v68, v106
    v_mov_b32 v69, v106
    v_mov_b32 v70, v106
    v_mov_b32 v71, v106
    v_mov_b32 v72, v106
    v_mov_b32 v73, v106
    v_mov_b32 v74, v106
    v_mov_b32 v75, v106
    v_mov_b32 v76, v106
    v_mov_b32 v77, v106
    v_mov_b32 v78, v106
    v_mov_b32 v79, v106
    v_sub_f32 v48, v48, v104
    v_sub_f32 v49, v49, v104
    v_sub_f32 v50, v50, v104
    v_sub_f32 v51, v51, v104
    v_sub_f32 v52, v52, v104
    v_sub_f32 v53, v53, v104
    v_sub_f32 v54, v54, v104
    v_sub_f32 v55, v55, v104
    v_sub_f32 v56, v56, v104
    v_sub_f32 v57, v57, v104
    v_sub_f32 v58, v58, v104
    v_sub_f32 v59, v59, v104
    v_sub_f32 v60, v60, v104
    v_sub_f32 v61, v61, v104
    v_sub_f32 v62, v62, v104
    v_sub_f32 v63, v63, v104
    v_sub_f32 v32, v32, v104
    v_sub_f32 v33, v33, v104
    v_sub_f32 v34, v34, v104
    v_sub_f32 v35, v35, v104
    v_sub_f32 v36, v36, v104
    v_sub_f32 v37, v37, v104
    v_sub_f32 v38, v38, v104
    v_sub_f32 v39, v39, v104
    v_sub_f32 v40, v40, v104
    v_sub_f32 v41, v41, v104
    v_sub_f32 v42, v42, v104
    v_sub_f32 v43, v43, v104
    v_sub_f32 v44, v44, v104
    v_sub_f32 v45, v45, v104
    v_sub_f32 v46, v46, v104
    v_sub_f32 v47, v47, v104
K2_FAST3:
    v_exp_f32 v48, v48
    v_exp_f32 v49, v49
    v_exp_f32 v50, v50
    v_exp_f32 v51, v51
    v_exp_f32 v52, v52
    v_exp_f32 v53, v53
    v_exp_f32 v54, v54
    v_exp_f32 v55, v55
    v_exp_f32 v56, v56
    v_exp_f32 v57, v57
    v_exp_f32 v58, v58
    v_exp_f32 v59, v59
    v_exp_f32 v60, v60
    v_exp_f32 v61, v61
    v_exp_f32 v62, v62
    v_exp_f32 v63, v63
    s_nop 0
    v_cvt_pk_bf16_f32 v96, v48, v49
    v_cvt_pk_bf16_f32 v97, v50, v51
    v_cvt_pk_bf16_f32 v98, v52, v53
    v_cvt_pk_bf16_f32 v99, v54, v55
    v_cvt_pk_bf16_f32 v100, v56, v57
    v_cvt_pk_bf16_f32 v101, v58, v59
    v_cvt_pk_bf16_f32 v102, v60, v61
    v_cvt_pk_bf16_f32 v103, v62, v63
    s_nop 1
    v_mfma_f32_32x32x16_bf16 v[80:95], v[24:27], v[96:99], v[80:95]
    v_mfma_f32_32x32x16_bf16 v[80:95], v[28:31], v[100:103], v[80:95]
    s_nop 7
    s_nop 7
    v_mov_b32 v12, v88
    v_mov_b32 v13, v88
    s_nop 1
    v_permlane32_swap_b32 v12, v13
    v_rcp_f32 v12, v12
    s_nop 0
    v_mul_f32 v32, v80, v12
    v_mul_f32 v33, v81, v12
    v_mul_f32 v34, v82, v12
    v_mul_f32 v35, v83, v12
    v_mul_f32 v36, v84, v12
    v_mul_f32 v37, v85, v12
    v_mul_f32 v38, v86, v12
    v_mul_f32 v39, v87, v12
    v_cvt_pk_bf16_f32 v96, v32, v33
    v_cvt_pk_bf16_f32 v97, v34, v35
    v_cvt_pk_bf16_f32 v98, v36, v37
    v_cvt_pk_bf16_f32 v99, v38, v39
    s_lshl_b32 s22, s21, 5
    s_add_u32 s22, s22, s3
    s_lshl_b32 s22, s22, 10
    s_add_u32 s22, s22, 12582912
    v_lshlrev_b32 v3, 4, v1
    buffer_store_dwordx4 v[96:99], v3, s[16:19], s22 offen
K2_END:
    s_endpgm
.p2align 8
.type final_kernel,@function
final_kernel:
    s_cmp_ge_u32 s2, 256
    s_cbranch_scc1 K3_END
    s_load_dwordx2 s[26:27], s[0:1], 16
    s_load_dwordx2 s[28:29], s[0:1], 40
    s_load_dwordx2 s[30:31], s[0:1], 56
    s_load_dwordx2 s[32:33], s[0:1], 72
    s_and_b32 s3, s2, 31
    s_lshr_b32 s4, s2, 5
    v_lshrrev_b32 v2, 6, v0
    v_and_b32 v1, 63, v0
    v_readfirstlane_b32 s5, v2
    s_nop 3
    s_and_b32 s6, s5, 1
    s_lshr_b32 s7, s5, 1
    s_waitcnt lgkmcnt(0)
    s_mov_b32 s8, s26
    s_and_b32 s9, s27, 0xffff
    s_mov_b32 s10, 524288
    s_mov_b32 s11, 0x00020000
    s_mov_b32 s12, s28
    s_and_b32 s13, s29, 0xffff
    s_mov_b32 s14, 1409024
    s_mov_b32 s15, 0x00020000
    s_mov_b32 s16, s32
    s_and_b32 s17, s33, 0xffff
    s_mov_b32 s18, 16777216
    s_mov_b32 s19, 0x00020000
    s_mov_b32 s20, s30
    s_and_b32 s21, s31, 0xffff
    s_mov_b32 s22, 2097152
    s_mov_b32 s23, 0x00020000
    s_lshl_b32 s24, s3, 1
    s_add_u32 s24, s24, s6
    s_lshl_b32 s25, s4, 1
    s_add_u32 s25, s25, s7
    v_lshrrev_b32 v2, 3, v1
    v_and_b32 v3, 7, v1
    v_bfe_u32 v4, v1, 4, 1
    v_lshlrev_b32 v4, 2, v4
    v_xor_b32 v3, v3, v4
    v_lshlrev_b32 v4, 10, v2
    v_lshl_add_u32 v4, v3, 4, v4
    s_lshl_b32 s34, s4, 7
    v_add_u32 v4, s34, v4
    v_lshlrev_b32 v11, 4, v1
    v_lshrrev_b32 v2, 5, v1
    v_lshlrev_b32 v2, 2, v2
    v_bfe_u32 v3, v1, 2, 2
    v_add_u32 v2, v2, v3
    v_lshlrev_b32 v9, 7, v2
    v_bfe_u32 v2, v1, 3, 1
    v_xor_b32 v2, s7, v2
    v_lshl_add_u32 v9, v2, 6, v9
    v_bfe_u32 v2, v1, 4, 1
    v_lshlrev_b32 v2, 5, v2
    v_and_b32 v3, 3, v1
    v_lshl_add_u32 v2, v3, 3, v2
    v_add_u32 v9, v9, v2
    v_add_u32 v10, 0x10000, v9
    s_lshl_b32 s34, s6, 13
    s_add_u32 s34, s34, 16384
    v_add_u32 v12, s34, v11
    v_add_u32 v13, 0x10000, v12
    v_mov_b32 v64, 0
    v_mov_b32 v65, 0
    v_mov_b32 v66, 0
    v_mov_b32 v67, 0
    v_mov_b32 v68, 0
    v_mov_b32 v69, 0
    v_mov_b32 v70, 0
    v_mov_b32 v71, 0
    v_mov_b32 v72, 0
    v_mov_b32 v73, 0
    v_mov_b32 v74, 0
    v_mov_b32 v75, 0
    v_mov_b32 v76, 0
    v_mov_b32 v77, 0
    v_mov_b32 v78, 0
    v_mov_b32 v79, 0
    v_mov_b32 v80, 0
    v_mov_b32 v81, 0
    v_mov_b32 v82, 0
    v_mov_b32 v83, 0
    v_mov_b32 v84, 0
    v_mov_b32 v85, 0
    v_mov_b32 v86, 0
    v_mov_b32 v87, 0
    v_mov_b32 v88, 0
    v_mov_b32 v89, 0
    v_mov_b32 v90, 0
    v_mov_b32 v91, 0
    v_mov_b32 v92, 0
    v_mov_b32 v93, 0
    v_mov_b32 v94, 0
    v_mov_b32 v95, 0
    s_lshl_b32 s40, s3, 1
    s_add_u32 s40, s40, s7
    s_lshl_b32 s36, s40, 15
    s_add_u32 s36, s36, 12582912
    s_mul_i32 s37, s40, 86
    s_lshl_b32 s37, s37, 10
    s_add_u32 s37, s37, 6291456
    s_lshl_b32 s41, s6, 12
    s_add_u32 s36, s36, s41
    s_add_u32 s37, s37, s41
    s_lshl_b32 s42, s7, 13
    s_add_u32 s42, s42, s41
    s_add_u32 s42, s42, 16384
    s_lshl_b32 s43, s5, 12
    s_lshl_b32 s44, s5, 15
    s_add_u32 s38, s44, 0
    s_add_u32 s39, s43, 0
    s_mov_b32 m0, s39
    s_nop 0
    buffer_load_dwordx4 v4, s[8:11], s38 offen lds
    s_add_u32 s38, s44, 8192
    s_add_u32 s39, s43, 1024
    s_mov_b32 m0, s39
    s_nop 0
    buffer_load_dwordx4 v4, s[8:11], s38 offen lds
    s_add_u32 s38, s44, 16384
    s_add_u32 s39, s43, 2048
    s_mov_b32 m0, s39
    s_nop 0
    buffer_load_dwordx4 v4, s[8:11], s38 offen lds
    s_add_u32 s38, s44, 24576
    s_add_u32 s39, s43, 3072
    s_mov_b32 m0, s39
    s_nop 0
    buffer_load_dwordx4 v4, s[8:11], s38 offen lds
    s_add_u32 s38, s36, 0
    s_add_u32 s39, s42, 0
    s_mov_b32 m0, s39
    s_nop 0
    buffer_load_dwordx4 v11, s[16:19], s38 offen lds
    s_add_u32 s38, s36, 1024
    s_add_u32 s39, s42, 1024
    s_mov_b32 m0, s39
    s_nop 0
    buffer_load_dwordx4 v11, s[16:19], s38 offen lds
    s_add_u32 s38, s36, 2048
    s_add_u32 s39, s42, 2048
    s_mov_b32 m0, s39
    s_nop 0
    buffer_load_dwordx4 v11, s[16:19], s38 offen lds
    s_add_u32 s38, s36, 3072
    s_add_u32 s39, s42, 3072
    s_mov_b32 m0, s39
    s_nop 0
    buffer_load_dwordx4 v11, s[16:19], s38 offen lds
    s_add_u32 s38, s44, 131072
    s_add_u32 s39, s43, 32768
    s_mov_b32 m0, s39
    s_nop 0
    buffer_load_dwordx4 v4, s[8:11], s38 offen lds
    s_add_u32 s38, s44, 139264
    s_add_u32 s39, s43, 33792
    s_mov_b32 m0, s39
    s_nop 0
    buffer_load_dwordx4 v4, s[8:11], s38 offen lds
    s_add_u32 s38, s44, 147456
    s_add_u32 s39, s43, 34816
    s_mov_b32 m0, s39
    s_nop 0
    buffer_load_dwordx4 v4, s[8:11], s38 offen lds
    s_add_u32 s38, s44, 155648
    s_add_u32 s39, s43, 35840
    s_mov_b32 m0, s39
    s_nop 0
    buffer_load_dwordx4 v4, s[8:11], s38 offen lds
    s_add_u32 s38, s36, 8192
    s_add_u32 s39, s42, 32768
    s_mov_b32 m0, s39
    s_nop 0
    buffer_load_dwordx4 v11, s[16:19], s38 offen lds
    s_add_u32 s38, s36, 9216
    s_add_u32 s39, s42, 33792
    s_mov_b32 m0, s39
    s_nop 0
    buffer_load_dwordx4 v11, s[16:19], s38 offen lds
    s_add_u32 s38, s36, 10240
    s_add_u32 s39, s42, 34816
    s_mov_b32 m0, s39
    s_nop 0
    buffer_load_dwordx4 v11, s[16:19], s38 offen lds
    s_add_u32 s38, s36, 11264
    s_add_u32 s39, s42, 35840
    s_mov_b32 m0, s39
    s_nop 0
    buffer_load_dwordx4 v11, s[16:19], s38 offen lds
    s_add_u32 s38, s44, 262144
    s_add_u32 s39, s43, 65536
    s_mov_b32 m0, s39
    s_nop 0
    buffer_load_dwordx4 v4, s[8:11], s38 offen lds
    s_add_u32 s38, s44, 270336
    s_add_u32 s39, s43, 66560
    s_mov_b32 m0, s39
    s_nop 0
    buffer_load_dwordx4 v4, s[8:11], s38 offen lds
    s_add_u32 s38, s44, 278528
    s_add_u32 s39, s43, 67584
    s_mov_b32 m0, s39
    s_nop 0
    buffer_load_dwordx4 v4, s[8:11], s38 offen lds
    s_add_u32 s38, s44, 286720
    s_add_u32 s39, s43, 68608
    s_mov_b32 m0, s39
    s_nop 0
    buffer_load_dwordx4 v4, s[8:11], s38 offen lds
    s_add_u32 s38, s36, 16384
    s_add_u32 s39, s42, 65536
    s_mov_b32 m0, s39
    s_nop 0
    buffer_load_dwordx4 v11, s[16:19], s38 offen lds
    s_add_u32 s38, s36, 17408
    s_add_u32 s39, s42, 66560
    s_mov_b32 m0, s39
    s_nop 0
    buffer_load_dwordx4 v11, s[16:19], s38 offen lds
    s_add_u32 s38, s36, 18432
    s_add_u32 s39, s42, 67584
    s_mov_b32 m0, s39
    s_nop 0
    buffer_load_dwordx4 v11, s[16:19], s38 offen lds
    s_add_u32 s38, s36, 19456
    s_add_u32 s39, s42, 68608
    s_mov_b32 m0, s39
    s_nop 0
    buffer_load_dwordx4 v11, s[16:19], s38 offen lds
    s_waitcnt vmcnt(16)
    s_barrier
    s_add_u32 s38, s44, 393216
    s_add_u32 s39, s43, 98304
    s_mov_b32 m0, s39
    s_nop 0
    buffer_load_dwordx4 v4, s[8:11], s38 offen lds
    s_add_u32 s38, s44, 401408
    s_add_u32 s39, s43, 99328
    s_mov_b32 m0, s39
    s_nop 0
    buffer_load_dwordx4 v4, s[8:11], s38 offen lds
    s_add_u32 s38, s44, 409600
    s_add_u32 s39, s43, 100352
    s_mov_b32 m0, s39
    s_nop 0
    buffer_load_dwordx4 v4, s[8:11], s38 offen lds
    s_add_u32 s38, s44, 417792
    s_add_u32 s39, s43, 101376
    s_mov_b32 m0, s39
    s_nop 0
    buffer_load_dwordx4 v4, s[8:11], s38 offen lds
    s_add_u32 s38, s36, 24576
    s_add_u32 s39, s42, 98304
    s_mov_b32 m0, s39
    s_nop 0
    buffer_load_dwordx4 v11, s[16:19], s38 offen lds
    s_add_u32 s38, s36, 25600
    s_add_u32 s39, s42, 99328
    s_mov_b32 m0, s39
    s_nop 0
    buffer_load_dwordx4 v11, s[16:19], s38 offen lds
    s_add_u32 s38, s36, 26624
    s_add_u32 s39, s42, 100352
    s_mov_b32 m0, s39
    s_nop 0
    buffer_load_dwordx4 v11, s[16:19], s38 offen lds
    s_add_u32 s38, s36, 27648
    s_add_u32 s39, s42, 101376
    s_mov_b32 m0, s39
    s_nop 0
    buffer_load_dwordx4 v11, s[16:19], s38 offen lds
    ds_read_b64_tr_b16 v[96:97], v9 offset:0
    ds_read_b64_tr_b16 v[98:99], v9 offset:1024
    ds_read_b128 v[16:19], v12 offset:0
    ds_read_b64_tr_b16 v[100:101], v9 offset:2048
    ds_read_b64_tr_b16 v[102:103], v9 offset:3072
    ds_read_b128 v[20:23], v12 offset:1024
    ds_read_b64_tr_b16 v[104:105], v9 offset:4096
    ds_read_b64_tr_b16 v[106:107], v9 offset:5120
    ds_read_b128 v[24:27], v12 offset:2048
    ds_read_b64_tr_b16 v[108:109], v9 offset:6144
    ds_read_b64_tr_b16 v[110:111], v9 offset:7168
    ds_read_b128 v[28:31], v12 offset:3072
    ds_read_b64_tr_b16 v[112:113], v9 offset:8192
    ds_read_b64_tr_b16 v[114:115], v9 offset:9216
    ds_read_b128 v[32:35], v12 offset:4096
    ds_read_b64_tr_b16 v[116:117], v9 offset:10240
    ds_read_b64_tr_b16 v[118:119], v9 offset:11264
    ds_read_b128 v[36:39], v12 offset:5120
    ds_read_b64_tr_b16 v[120:121], v9 offset:12288
    ds_read_b64_tr_b16 v[122:123], v9 offset:13312
    ds_read_b128 v[40:43], v12 offset:6144
    ds_read_b64_tr_b16 v[124:125], v9 offset:14336
    ds_read_b64_tr_b16 v[126:127], v9 offset:15360
    ds_read_b128 v[44:47], v12 offset:7168
    s_waitcnt lgkmcnt(15)
    v_mfma_f32_32x32x16_bf16 v[64:79], v[96:99], v[16:19], v[64:79]
    s_waitcnt lgkmcnt(15)
    v_mfma_f32_32x32x16_bf16 v[64:79], v[100:103], v[20:23], v[64:79]
    s_waitcnt lgkmcnt(15)
    v_mfma_f32_32x32x16_bf16 v[64:79], v[104:107], v[24:27], v[64:79]
    s_waitcnt lgkmcnt(12)
    v_mfma_f32_32x32x16_bf16 v[64:79], v[108:111], v[28:31], v[64:79]
    s_waitcnt lgkmcnt(9)
    v_mfma_f32_32x32x16_bf16 v[64:79], v[112:115], v[32:35], v[64:79]
    s_waitcnt lgkmcnt(6)
    v_mfma_f32_32x32x16_bf16 v[64:79], v[116:119], v[36:39], v[64:79]
    s_waitcnt lgkmcnt(3)
    v_mfma_f32_32x32x16_bf16 v[64:79], v[120:123], v[40:43], v[64:79]
    s_waitcnt lgkmcnt(0)
    v_mfma_f32_32x32x16_bf16 v[64:79], v[124:127], v[44:47], v[64:79]
    s_waitcnt vmcnt(16)
    s_barrier
    s_add_u32 s38, s44, 0
    s_add_u32 s39, s43, 0
    s_mov_b32 m0, s39
    s_nop 0
    buffer_load_dwordx4 v4, s[12:15], s38 offen lds
    s_add_u32 s38, s44, 8192
    s_add_u32 s39, s43, 1024
    s_mov_b32 m0, s39
    s_nop 0
    buffer_load_dwordx4 v4, s[12:15], s38 offen lds
    s_add_u32 s38, s44, 16384
    s_add_u32 s39, s43, 2048
    s_mov_b32 m0, s39
    s_nop 0
    buffer_load_dwordx4 v4, s[12:15], s38 offen lds
    s_add_u32 s38, s44, 24576
    s_add_u32 s39, s43, 3072
    s_mov_b32 m0, s39
    s_nop 0
    buffer_load_dwordx4 v4, s[12:15], s38 offen lds
    s_add_u32 s38, s37, 0
    s_add_u32 s39, s42, 0
    s_mov_b32 m0, s39
    s_nop 0
    buffer_load_dwordx4 v11, s[16:19], s38 offen lds
    s_add_u32 s38, s37, 1024
    s_add_u32 s39, s42, 1024
    s_mov_b32 m0, s39
    s_nop 0
    buffer_load_dwordx4 v11, s[16:19], s38 offen lds
    s_add_u32 s38, s37, 2048
    s_add_u32 s39, s42, 2048
    s_mov_b32 m0, s39
    s_nop 0
    buffer_load_dwordx4 v11, s[16:19], s38 offen lds
    s_add_u32 s38, s37, 3072
    s_add_u32 s39, s42, 3072
    s_mov_b32 m0, s39
    s_nop 0
    buffer_load_dwordx4 v11, s[16:19], s38 offen lds
    ds_read_b64_tr_b16 v[96:97], v9 offset:32768
    ds_read_b64_tr_b16 v[98:99], v9 offset:33792
    ds_read_b128 v[16:19], v12 offset:32768
    ds_read_b64_tr_b16 v[100:101], v9 offset:34816
    ds_read_b64_tr_b16 v[102:103], v9 offset:35840
    ds_read_b128 v[20:23], v12 offset:33792
    ds_read_b64_tr_b16 v[104:105], v9 offset:36864
    ds_read_b64_tr_b16 v[106:107], v9 offset:37888
    ds_read_b128 v[24:27], v12 offset:34816
    ds_read_b64_tr_b16 v[108:109], v9 offset:38912
    ds_read_b64_tr_b16 v[110:111], v9 offset:39936
    ds_read_b128 v[28:31], v12 offset:35840
    ds_read_b64_tr_b16 v[112:113], v9 offset:40960
    ds_read_b64_tr_b16 v[114:115], v9 offset:41984
    ds_read_b128 v[32:35], v12 offset:36864
    ds_read_b64_tr_b16 v[116:117], v9 offset:43008
    ds_read_b64_tr_b16 v[118:119], v9 offset:44032
    ds_read_b128 v[36:39], v12 offset:37888
    ds_read_b64_tr_b16 v[120:121], v9 offset:45056
    ds_read_b64_tr_b16 v[122:123], v9 offset:46080
    ds_read_b128 v[40:43], v12 offset:38912
    ds_read_b64_tr_b16 v[124:125], v9 offset:47104
    ds_read_b64_tr_b16 v[126:127], v9 offset:48128
    ds_read_b128 v[44:47], v12 offset:39936
    s_waitcnt lgkmcnt(15)
    v_mfma_f32_32x32x16_bf16 v[64:79], v[96:99], v[16:19], v[64:79]
    s_waitcnt lgkmcnt(15)
    v_mfma_f32_32x32x16_bf16 v[64:79], v[100:103], v[20:23], v[64:79]
    s_waitcnt lgkmcnt(15)
    v_mfma_f32_32x32x16_bf16 v[64:79], v[104:107], v[24:27], v[64:79]
    s_waitcnt lgkmcnt(12)
    v_mfma_f32_32x32x16_bf16 v[64:79], v[108:111], v[28:31], v[64:79]
    s_waitcnt lgkmcnt(9)
    v_mfma_f32_32x32x16_bf16 v[64:79], v[112:115], v[32:35], v[64:79]
    s_waitcnt lgkmcnt(6)
    v_mfma_f32_32x32x16_bf16 v[64:79], v[116:119], v[36:39], v[64:79]
    s_waitcnt lgkmcnt(3)
    v_mfma_f32_32x32x16_bf16 v[64:79], v[120:123], v[40:43], v[64:79]
    s_waitcnt lgkmcnt(0)
    v_mfma_f32_32x32x16_bf16 v[64:79], v[124:127], v[44:47], v[64:79]
    s_waitcnt vmcnt(16)
    s_barrier
    s_add_u32 s38, s44, 131072
    s_add_u32 s39, s43, 32768
    s_mov_b32 m0, s39
    s_nop 0
    buffer_load_dwordx4 v4, s[12:15], s38 offen lds
    s_add_u32 s38, s44, 139264
    s_add_u32 s39, s43, 33792
    s_mov_b32 m0, s39
    s_nop 0
    buffer_load_dwordx4 v4, s[12:15], s38 offen lds
    s_add_u32 s38, s44, 147456
    s_add_u32 s39, s43, 34816
    s_mov_b32 m0, s39
    s_nop 0
    buffer_load_dwordx4 v4, s[12:15], s38 offen lds
    s_add_u32 s38, s44, 155648
    s_add_u32 s39, s43, 35840
    s_mov_b32 m0, s39
    s_nop 0
    buffer_load_dwordx4 v4, s[12:15], s38 offen lds
    s_add_u32 s38, s37, 8192
    s_add_u32 s39, s42, 32768
    s_mov_b32 m0, s39
    s_nop 0
    buffer_load_dwordx4 v11, s[16:19], s38 offen lds
    s_add_u32 s38, s37, 9216
    s_add_u32 s39, s42, 33792
    s_mov_b32 m0, s39
    s_nop 0
    buffer_load_dwordx4 v11, s[16:19], s38 offen lds
    s_add_u32 s38, s37, 10240
    s_add_u32 s39, s42, 34816
    s_mov_b32 m0, s39
    s_nop 0
    buffer_load_dwordx4 v11, s[16:19], s38 offen lds
    s_add_u32 s38, s37, 11264
    s_add_u32 s39, s42, 35840
    s_mov_b32 m0, s39
    s_nop 0
    buffer_load_dwordx4 v11, s[16:19], s38 offen lds
    ds_read_b64_tr_b16 v[96:97], v10 offset:0
    ds_read_b64_tr_b16 v[98:99], v10 offset:1024
    ds_read_b128 v[16:19], v13 offset:0
    ds_read_b64_tr_b16 v[100:101], v10 offset:2048
    ds_read_b64_tr_b16 v[102:103], v10 offset:3072
    ds_read_b128 v[20:23], v13 offset:1024
    ds_read_b64_tr_b16 v[104:105], v10 offset:4096
    ds_read_b64_tr_b16 v[106:107], v10 offset:5120
    ds_read_b128 v[24:27], v13 offset:2048
    ds_read_b64_tr_b16 v[108:109], v10 offset:6144
    ds_read_b64_tr_b16 v[110:111], v10 offset:7168
    ds_read_b128 v[28:31], v13 offset:3072
    ds_read_b64_tr_b16 v[112:113], v10 offset:8192
    ds_read_b64_tr_b16 v[114:115], v10 offset:9216
    ds_read_b128 v[32:35], v13 offset:4096
    ds_read_b64_tr_b16 v[116:117], v10 offset:10240
    ds_read_b64_tr_b16 v[118:119], v10 offset:11264
    ds_read_b128 v[36:39], v13 offset:5120
    ds_read_b64_tr_b16 v[120:121], v10 offset:12288
    ds_read_b64_tr_b16 v[122:123], v10 offset:13312
    ds_read_b128 v[40:43], v13 offset:6144
    ds_read_b64_tr_b16 v[124:125], v10 offset:14336
    ds_read_b64_tr_b16 v[126:127], v10 offset:15360
    ds_read_b128 v[44:47], v13 offset:7168
    s_waitcnt lgkmcnt(15)
    v_mfma_f32_32x32x16_bf16 v[64:79], v[96:99], v[16:19], v[64:79]
    s_waitcnt lgkmcnt(15)
    v_mfma_f32_32x32x16_bf16 v[64:79], v[100:103], v[20:23], v[64:79]
    s_waitcnt lgkmcnt(15)
    v_mfma_f32_32x32x16_bf16 v[64:79], v[104:107], v[24:27], v[64:79]
    s_waitcnt lgkmcnt(12)
    v_mfma_f32_32x32x16_bf16 v[64:79], v[108:111], v[28:31], v[64:79]
    s_waitcnt lgkmcnt(9)
    v_mfma_f32_32x32x16_bf16 v[64:79], v[112:115], v[32:35], v[64:79]
    s_waitcnt lgkmcnt(6)
    v_mfma_f32_32x32x16_bf16 v[64:79], v[116:119], v[36:39], v[64:79]
    s_waitcnt lgkmcnt(3)
    v_mfma_f32_32x32x16_bf16 v[64:79], v[120:123], v[40:43], v[64:79]
    s_waitcnt lgkmcnt(0)
    v_mfma_f32_32x32x16_bf16 v[64:79], v[124:127], v[44:47], v[64:79]
    s_waitcnt vmcnt(16)
    s_barrier
    s_add_u32 s38, s44, 262144
    s_add_u32 s39, s43, 65536
    s_mov_b32 m0, s39
    s_nop 0
    buffer_load_dwordx4 v4, s[12:15], s38 offen lds
    s_add_u32 s38, s44, 270336
    s_add_u32 s39, s43, 66560
    s_mov_b32 m0, s39
    s_nop 0
    buffer_load_dwordx4 v4, s[12:15], s38 offen lds
    s_add_u32 s38, s44, 278528
    s_add_u32 s39, s43, 67584
    s_mov_b32 m0, s39
    s_nop 0
    buffer_load_dwordx4 v4, s[12:15], s38 offen lds
    s_add_u32 s38, s44, 286720
    s_add_u32 s39, s43, 68608
    s_mov_b32 m0, s39
    s_nop 0
    buffer_load_dwordx4 v4, s[12:15], s38 offen lds
    s_add_u32 s38, s37, 16384
    s_add_u32 s39, s42, 65536
    s_mov_b32 m0, s39
    s_nop 0
    buffer_load_dwordx4 v11, s[16:19], s38 offen lds
    s_add_u32 s38, s37, 17408
    s_add_u32 s39, s42, 66560
    s_mov_b32 m0, s39
    s_nop 0
    buffer_load_dwordx4 v11, s[16:19], s38 offen lds
    s_add_u32 s38, s37, 18432
    s_add_u32 s39, s42, 67584
    s_mov_b32 m0, s39
    s_nop 0
    buffer_load_dwordx4 v11, s[16:19], s38 offen lds
    s_add_u32 s38, s37, 19456
    s_add_u32 s39, s42, 68608
    s_mov_b32 m0, s39
    s_nop 0
    buffer_load_dwordx4 v11, s[16:19], s38 offen lds
    ds_read_b64_tr_b16 v[96:97], v10 offset:32768
    ds_read_b64_tr_b16 v[98:99], v10 offset:33792
    ds_read_b128 v[16:19], v13 offset:32768
    ds_read_b64_tr_b16 v[100:101], v10 offset:34816
    ds_read_b64_tr_b16 v[102:103], v10 offset:35840
    ds_read_b128 v[20:23], v13 offset:33792
    ds_read_b64_tr_b16 v[104:105], v10 offset:36864
    ds_read_b64_tr_b16 v[106:107], v10 offset:37888
    ds_read_b128 v[24:27], v13 offset:34816
    ds_read_b64_tr_b16 v[108:109], v10 offset:38912
    ds_read_b64_tr_b16 v[110:111], v10 offset:39936
    ds_read_b128 v[28:31], v13 offset:35840
    ds_read_b64_tr_b16 v[112:113], v10 offset:40960
    ds_read_b64_tr_b16 v[114:115], v10 offset:41984
    ds_read_b128 v[32:35], v13 offset:36864
    ds_read_b64_tr_b16 v[116:117], v10 offset:43008
    ds_read_b64_tr_b16 v[118:119], v10 offset:44032
    ds_read_b128 v[36:39], v13 offset:37888
    ds_read_b64_tr_b16 v[120:121], v10 offset:45056
    ds_read_b64_tr_b16 v[122:123], v10 offset:46080
    ds_read_b128 v[40:43], v13 offset:38912
    ds_read_b64_tr_b16 v[124:125], v10 offset:47104
    ds_read_b64_tr_b16 v[126:127], v10 offset:48128
    ds_read_b128 v[44:47], v13 offset:39936
    s_waitcnt lgkmcnt(15)
    v_mfma_f32_32x32x16_bf16 v[64:79], v[96:99], v[16:19], v[64:79]
    s_waitcnt lgkmcnt(15)
    v_mfma_f32_32x32x16_bf16 v[64:79], v[100:103], v[20:23], v[64:79]
    s_waitcnt lgkmcnt(15)
    v_mfma_f32_32x32x16_bf16 v[64:79], v[104:107], v[24:27], v[64:79]
    s_waitcnt lgkmcnt(12)
    v_mfma_f32_32x32x16_bf16 v[64:79], v[108:111], v[28:31], v[64:79]
    s_waitcnt lgkmcnt(9)
    v_mfma_f32_32x32x16_bf16 v[64:79], v[112:115], v[32:35], v[64:79]
    s_waitcnt lgkmcnt(6)
    v_mfma_f32_32x32x16_bf16 v[64:79], v[116:119], v[36:39], v[64:79]
    s_waitcnt lgkmcnt(3)
    v_mfma_f32_32x32x16_bf16 v[64:79], v[120:123], v[40:43], v[64:79]
    s_waitcnt lgkmcnt(0)
    v_mfma_f32_32x32x16_bf16 v[64:79], v[124:127], v[44:47], v[64:79]
    s_waitcnt vmcnt(16)
    s_barrier
    s_add_u32 s38, s44, 393216
    s_add_u32 s39, s43, 98304
    s_mov_b32 m0, s39
    s_nop 0
    buffer_load_dwordx4 v4, s[12:15], s38 offen lds
    s_add_u32 s38, s44, 401408
    s_add_u32 s39, s43, 99328
    s_mov_b32 m0, s39
    s_nop 0
    buffer_load_dwordx4 v4, s[12:15], s38 offen lds
    s_add_u32 s38, s44, 409600
    s_add_u32 s39, s43, 100352
    s_mov_b32 m0, s39
    s_nop 0
    buffer_load_dwordx4 v4, s[12:15], s38 offen lds
    s_add_u32 s38, s44, 417792
    s_add_u32 s39, s43, 101376
    s_mov_b32 m0, s39
    s_nop 0
    buffer_load_dwordx4 v4, s[12:15], s38 offen lds
    s_add_u32 s38, s37, 24576
    s_add_u32 s39, s42, 98304
    s_mov_b32 m0, s39
    s_nop 0
    buffer_load_dwordx4 v11, s[16:19], s38 offen lds
    s_add_u32 s38, s37, 25600
    s_add_u32 s39, s42, 99328
    s_mov_b32 m0, s39
    s_nop 0
    buffer_load_dwordx4 v11, s[16:19], s38 offen lds
    s_add_u32 s38, s37, 26624
    s_add_u32 s39, s42, 100352
    s_mov_b32 m0, s39
    s_nop 0
    buffer_load_dwordx4 v11, s[16:19], s38 offen lds
    s_add_u32 s38, s37, 27648
    s_add_u32 s39, s42, 101376
    s_mov_b32 m0, s39
    s_nop 0
    buffer_load_dwordx4 v11, s[16:19], s38 offen lds
    ds_read_b64_tr_b16 v[96:97], v9 offset:0
    ds_read_b64_tr_b16 v[98:99], v9 offset:1024
    ds_read_b128 v[16:19], v12 offset:0
    ds_read_b64_tr_b16 v[100:101], v9 offset:2048
    ds_read_b64_tr_b16 v[102:103], v9 offset:3072
    ds_read_b128 v[20:23], v12 offset:1024
    ds_read_b64_tr_b16 v[104:105], v9 offset:4096
    ds_read_b64_tr_b16 v[106:107], v9 offset:5120
    ds_read_b128 v[24:27], v12 offset:2048
    ds_read_b64_tr_b16 v[108:109], v9 offset:6144
    ds_read_b64_tr_b16 v[110:111], v9 offset:7168
    ds_read_b128 v[28:31], v12 offset:3072
    ds_read_b64_tr_b16 v[112:113], v9 offset:8192
    ds_read_b64_tr_b16 v[114:115], v9 offset:9216
    ds_read_b128 v[32:35], v12 offset:4096
    ds_read_b64_tr_b16 v[116:117], v9 offset:10240
    ds_read_b64_tr_b16 v[118:119], v9 offset:11264
    ds_read_b128 v[36:39], v12 offset:5120
    ds_read_b64_tr_b16 v[120:121], v9 offset:12288
    ds_read_b64_tr_b16 v[122:123], v9 offset:13312
    ds_read_b128 v[40:43], v12 offset:6144
    ds_read_b64_tr_b16 v[124:125], v9 offset:14336
    ds_read_b64_tr_b16 v[126:127], v9 offset:15360
    ds_read_b128 v[44:47], v12 offset:7168
    s_waitcnt lgkmcnt(15)
    v_mfma_f32_32x32x16_bf16 v[80:95], v[96:99], v[16:19], v[80:95]
    s_waitcnt lgkmcnt(15)
    v_mfma_f32_32x32x16_bf16 v[80:95], v[100:103], v[20:23], v[80:95]
    s_waitcnt lgkmcnt(15)
    v_mfma_f32_32x32x16_bf16 v[80:95], v[104:107], v[24:27], v[80:95]
    s_waitcnt lgkmcnt(12)
    v_mfma_f32_32x32x16_bf16 v[80:95], v[108:111], v[28:31], v[80:95]
    s_waitcnt lgkmcnt(9)
    v_mfma_f32_32x32x16_bf16 v[80:95], v[112:115], v[32:35], v[80:95]
    s_waitcnt lgkmcnt(6)
    v_mfma_f32_32x32x16_bf16 v[80:95], v[116:119], v[36:39], v[80:95]
    s_waitcnt lgkmcnt(3)
    v_mfma_f32_32x32x16_bf16 v[80:95], v[120:123], v[40:43], v[80:95]
    s_waitcnt lgkmcnt(0)
    v_mfma_f32_32x32x16_bf16 v[80:95], v[124:127], v[44:47], v[80:95]
    s_waitcnt vmcnt(16)
    s_barrier
    s_add_u32 s38, s44, 524288
    s_add_u32 s39, s43, 0
    s_mov_b32 m0, s39
    s_nop 0
    buffer_load_dwordx4 v4, s[12:15], s38 offen lds
    s_add_u32 s38, s44, 532480
    s_add_u32 s39, s43, 1024
    s_mov_b32 m0, s39
    s_nop 0
    buffer_load_dwordx4 v4, s[12:15], s38 offen lds
    s_add_u32 s38, s44, 540672
    s_add_u32 s39, s43, 2048
    s_mov_b32 m0, s39
    s_nop 0
    buffer_load_dwordx4 v4, s[12:15], s38 offen lds
    s_add_u32 s38, s44, 548864
    s_add_u32 s39, s43, 3072
    s_mov_b32 m0, s39
    s_nop 0
    buffer_load_dwordx4 v4, s[12:15], s38 offen lds
    s_add_u32 s38, s37, 32768
    s_add_u32 s39, s42, 0
    s_mov_b32 m0, s39
    s_nop 0
    buffer_load_dwordx4 v11, s[16:19], s38 offen lds
    s_add_u32 s38, s37, 33792
    s_add_u32 s39, s42, 1024
    s_mov_b32 m0, s39
    s_nop 0
    buffer_load_dwordx4 v11, s[16:19], s38 offen lds
    s_add_u32 s38, s37, 34816
    s_add_u32 s39, s42, 2048
    s_mov_b32 m0, s39
    s_nop 0
    buffer_load_dwordx4 v11, s[16:19], s38 offen lds
    s_add_u32 s38, s37, 35840
    s_add_u32 s39, s42, 3072
    s_mov_b32 m0, s39
    s_nop 0
    buffer_load_dwordx4 v11, s[16:19], s38 offen lds
    ds_read_b64_tr_b16 v[96:97], v9 offset:32768
    ds_read_b64_tr_b16 v[98:99], v9 offset:33792
    ds_read_b128 v[16:19], v12 offset:32768
    ds_read_b64_tr_b16 v[100:101], v9 offset:34816
    ds_read_b64_tr_b16 v[102:103], v9 offset:35840
    ds_read_b128 v[20:23], v12 offset:33792
    ds_read_b64_tr_b16 v[104:105], v9 offset:36864
    ds_read_b64_tr_b16 v[106:107], v9 offset:37888
    ds_read_b128 v[24:27], v12 offset:34816
    ds_read_b64_tr_b16 v[108:109], v9 offset:38912
    ds_read_b64_tr_b16 v[110:111], v9 offset:39936
    ds_read_b128 v[28:31], v12 offset:35840
    ds_read_b64_tr_b16 v[112:113], v9 offset:40960
    ds_read_b64_tr_b16 v[114:115], v9 offset:41984
    ds_read_b128 v[32:35], v12 offset:36864
    ds_read_b64_tr_b16 v[116:117], v9 offset:43008
    ds_read_b64_tr_b16 v[118:119], v9 offset:44032
    ds_read_b128 v[36:39], v12 offset:37888
    ds_read_b64_tr_b16 v[120:121], v9 offset:45056
    ds_read_b64_tr_b16 v[122:123], v9 offset:46080
    ds_read_b128 v[40:43], v12 offset:38912
    ds_read_b64_tr_b16 v[124:125], v9 offset:47104
    ds_read_b64_tr_b16 v[126:127], v9 offset:48128
    ds_read_b128 v[44:47], v12 offset:39936
    s_waitcnt lgkmcnt(15)
    v_mfma_f32_32x32x16_bf16 v[80:95], v[96:99], v[16:19], v[80:95]
    s_waitcnt lgkmcnt(15)
    v_mfma_f32_32x32x16_bf16 v[80:95], v[100:103], v[20:23], v[80:95]
    s_waitcnt lgkmcnt(15)
    v_mfma_f32_32x32x16_bf16 v[80:95], v[104:107], v[24:27], v[80:95]
    s_waitcnt lgkmcnt(12)
    v_mfma_f32_32x32x16_bf16 v[80:95], v[108:111], v[28:31], v[80:95]
    s_waitcnt lgkmcnt(9)
    v_mfma_f32_32x32x16_bf16 v[80:95], v[112:115], v[32:35], v[80:95]
    s_waitcnt lgkmcnt(6)
    v_mfma_f32_32x32x16_bf16 v[80:95], v[116:119], v[36:39], v[80:95]
    s_waitcnt lgkmcnt(3)
    v_mfma_f32_32x32x16_bf16 v[80:95], v[120:123], v[40:43], v[80:95]
    s_waitcnt lgkmcnt(0)
    v_mfma_f32_32x32x16_bf16 v[80:95], v[124:127], v[44:47], v[80:95]
    s_waitcnt vmcnt(16)
    s_barrier
    s_add_u32 s38, s44, 655360
    s_add_u32 s39, s43, 32768
    s_mov_b32 m0, s39
    s_nop 0
    buffer_load_dwordx4 v4, s[12:15], s38 offen lds
    s_add_u32 s38, s44, 663552
    s_add_u32 s39, s43, 33792
    s_mov_b32 m0, s39
    s_nop 0
    buffer_load_dwordx4 v4, s[12:15], s38 offen lds
    s_add_u32 s38, s44, 671744
    s_add_u32 s39, s43, 34816
    s_mov_b32 m0, s39
    s_nop 0
    buffer_load_dwordx4 v4, s[12:15], s38 offen lds
    s_add_u32 s38, s44, 679936
    s_add_u32 s39, s43, 35840
    s_mov_b32 m0, s39
    s_nop 0
    buffer_load_dwordx4 v4, s[12:15], s38 offen lds
    s_add_u32 s38, s37, 40960
    s_add_u32 s39, s42, 32768
    s_mov_b32 m0, s39
    s_nop 0
    buffer_load_dwordx4 v11, s[16:19], s38 offen lds
    s_add_u32 s38, s37, 41984
    s_add_u32 s39, s42, 33792
    s_mov_b32 m0, s39
    s_nop 0
    buffer_load_dwordx4 v11, s[16:19], s38 offen lds
    s_add_u32 s38, s37, 43008
    s_add_u32 s39, s42, 34816
    s_mov_b32 m0, s39
    s_nop 0
    buffer_load_dwordx4 v11, s[16:19], s38 offen lds
    s_add_u32 s38, s37, 44032
    s_add_u32 s39, s42, 35840
    s_mov_b32 m0, s39
    s_nop 0
    buffer_load_dwordx4 v11, s[16:19], s38 offen lds
    ds_read_b64_tr_b16 v[96:97], v10 offset:0
    ds_read_b64_tr_b16 v[98:99], v10 offset:1024
    ds_read_b128 v[16:19], v13 offset:0
    ds_read_b64_tr_b16 v[100:101], v10 offset:2048
    ds_read_b64_tr_b16 v[102:103], v10 offset:3072
    ds_read_b128 v[20:23], v13 offset:1024
    ds_read_b64_tr_b16 v[104:105], v10 offset:4096
    ds_read_b64_tr_b16 v[106:107], v10 offset:5120
    ds_read_b128 v[24:27], v13 offset:2048
    ds_read_b64_tr_b16 v[108:109], v10 offset:6144
    ds_read_b64_tr_b16 v[110:111], v10 offset:7168
    ds_read_b128 v[28:31], v13 offset:3072
    ds_read_b64_tr_b16 v[112:113], v10 offset:8192
    ds_read_b64_tr_b16 v[114:115], v10 offset:9216
    ds_read_b128 v[32:35], v13 offset:4096
    ds_read_b64_tr_b16 v[116:117], v10 offset:10240
    ds_read_b64_tr_b16 v[118:119], v10 offset:11264
    ds_read_b128 v[36:39], v13 offset:5120
    ds_read_b64_tr_b16 v[120:121], v10 offset:12288
    ds_read_b64_tr_b16 v[122:123], v10 offset:13312
    ds_read_b128 v[40:43], v13 offset:6144
    ds_read_b64_tr_b16 v[124:125], v10 offset:14336
    ds_read_b64_tr_b16 v[126:127], v10 offset:15360
    ds_read_b128 v[44:47], v13 offset:7168
    s_waitcnt lgkmcnt(15)
    v_mfma_f32_32x32x16_bf16 v[80:95], v[96:99], v[16:19], v[80:95]
    s_waitcnt lgkmcnt(15)
    v_mfma_f32_32x32x16_bf16 v[80:95], v[100:103], v[20:23], v[80:95]
    s_waitcnt lgkmcnt(15)
    v_mfma_f32_32x32x16_bf16 v[80:95], v[104:107], v[24:27], v[80:95]
    s_waitcnt lgkmcnt(12)
    v_mfma_f32_32x32x16_bf16 v[80:95], v[108:111], v[28:31], v[80:95]
    s_waitcnt lgkmcnt(9)
    v_mfma_f32_32x32x16_bf16 v[80:95], v[112:115], v[32:35], v[80:95]
    s_waitcnt lgkmcnt(6)
    v_mfma_f32_32x32x16_bf16 v[80:95], v[116:119], v[36:39], v[80:95]
    s_waitcnt lgkmcnt(3)
    v_mfma_f32_32x32x16_bf16 v[80:95], v[120:123], v[40:43], v[80:95]
    s_waitcnt lgkmcnt(0)
    v_mfma_f32_32x32x16_bf16 v[80:95], v[124:127], v[44:47], v[80:95]
    s_waitcnt vmcnt(16)
    s_barrier
    s_add_u32 s38, s44, 786432
    s_add_u32 s39, s43, 65536
    s_mov_b32 m0, s39
    s_nop 0
    buffer_load_dwordx4 v4, s[12:15], s38 offen lds
    s_add_u32 s38, s44, 794624
    s_add_u32 s39, s43, 66560
    s_mov_b32 m0, s39
    s_nop 0
    buffer_load_dwordx4 v4, s[12:15], s38 offen lds
    s_add_u32 s38, s44, 802816
    s_add_u32 s39, s43, 67584
    s_mov_b32 m0, s39
    s_nop 0
    buffer_load_dwordx4 v4, s[12:15], s38 offen lds
    s_add_u32 s38, s44, 811008
    s_add_u32 s39, s43, 68608
    s_mov_b32 m0, s39
    s_nop 0
    buffer_load_dwordx4 v4, s[12:15], s38 offen lds
    s_add_u32 s38, s37, 49152
    s_add_u32 s39, s42, 65536
    s_mov_b32 m0, s39
    s_nop 0
    buffer_load_dwordx4 v11, s[16:19], s38 offen lds
    s_add_u32 s38, s37, 50176
    s_add_u32 s39, s42, 66560
    s_mov_b32 m0, s39
    s_nop 0
    buffer_load_dwordx4 v11, s[16:19], s38 offen lds
    s_add_u32 s38, s37, 51200
    s_add_u32 s39, s42, 67584
    s_mov_b32 m0, s39
    s_nop 0
    buffer_load_dwordx4 v11, s[16:19], s38 offen lds
    s_add_u32 s38, s37, 52224
    s_add_u32 s39, s42, 68608
    s_mov_b32 m0, s39
    s_nop 0
    buffer_load_dwordx4 v11, s[16:19], s38 offen lds
    ds_read_b64_tr_b16 v[96:97], v10 offset:32768
    ds_read_b64_tr_b16 v[98:99], v10 offset:33792
    ds_read_b128 v[16:19], v13 offset:32768
    ds_read_b64_tr_b16 v[100:101], v10 offset:34816
    ds_read_b64_tr_b16 v[102:103], v10 offset:35840
    ds_read_b128 v[20:23], v13 offset:33792
    ds_read_b64_tr_b16 v[104:105], v10 offset:36864
    ds_read_b64_tr_b16 v[106:107], v10 offset:37888
    ds_read_b128 v[24:27], v13 offset:34816
    ds_read_b64_tr_b16 v[108:109], v10 offset:38912
    ds_read_b64_tr_b16 v[110:111], v10 offset:39936
    ds_read_b128 v[28:31], v13 offset:35840
    ds_read_b64_tr_b16 v[112:113], v10 offset:40960
    ds_read_b64_tr_b16 v[114:115], v10 offset:41984
    ds_read_b128 v[32:35], v13 offset:36864
    ds_read_b64_tr_b16 v[116:117], v10 offset:43008
    ds_read_b64_tr_b16 v[118:119], v10 offset:44032
    ds_read_b128 v[36:39], v13 offset:37888
    ds_read_b64_tr_b16 v[120:121], v10 offset:45056
    ds_read_b64_tr_b16 v[122:123], v10 offset:46080
    ds_read_b128 v[40:43], v13 offset:38912
    ds_read_b64_tr_b16 v[124:125], v10 offset:47104
    ds_read_b64_tr_b16 v[126:127], v10 offset:48128
    ds_read_b128 v[44:47], v13 offset:39936
    s_waitcnt lgkmcnt(15)
    v_mfma_f32_32x32x16_bf16 v[80:95], v[96:99], v[16:19], v[80:95]
    s_waitcnt lgkmcnt(15)
    v_mfma_f32_32x32x16_bf16 v[80:95], v[100:103], v[20:23], v[80:95]
    s_waitcnt lgkmcnt(15)
    v_mfma_f32_32x32x16_bf16 v[80:95], v[104:107], v[24:27], v[80:95]
    s_waitcnt lgkmcnt(12)
    v_mfma_f32_32x32x16_bf16 v[80:95], v[108:111], v[28:31], v[80:95]
    s_waitcnt lgkmcnt(9)
    v_mfma_f32_32x32x16_bf16 v[80:95], v[112:115], v[32:35], v[80:95]
    s_waitcnt lgkmcnt(6)
    v_mfma_f32_32x32x16_bf16 v[80:95], v[116:119], v[36:39], v[80:95]
    s_waitcnt lgkmcnt(3)
    v_mfma_f32_32x32x16_bf16 v[80:95], v[120:123], v[40:43], v[80:95]
    s_waitcnt lgkmcnt(0)
    v_mfma_f32_32x32x16_bf16 v[80:95], v[124:127], v[44:47], v[80:95]
    s_waitcnt vmcnt(16)
    s_barrier
    s_add_u32 s38, s44, 917504
    s_add_u32 s39, s43, 98304
    s_mov_b32 m0, s39
    s_nop 0
    buffer_load_dwordx4 v4, s[12:15], s38 offen lds
    s_add_u32 s38, s44, 925696
    s_add_u32 s39, s43, 99328
    s_mov_b32 m0, s39
    s_nop 0
    buffer_load_dwordx4 v4, s[12:15], s38 offen lds
    s_add_u32 s38, s44, 933888
    s_add_u32 s39, s43, 100352
    s_mov_b32 m0, s39
    s_nop 0
    buffer_load_dwordx4 v4, s[12:15], s38 offen lds
    s_add_u32 s38, s44, 942080
    s_add_u32 s39, s43, 101376
    s_mov_b32 m0, s39
    s_nop 0
    buffer_load_dwordx4 v4, s[12:15], s38 offen lds
    s_add_u32 s38, s37, 57344
    s_add_u32 s39, s42, 98304
    s_mov_b32 m0, s39
    s_nop 0
    buffer_load_dwordx4 v11, s[16:19], s38 offen lds
    s_add_u32 s38, s37, 58368
    s_add_u32 s39, s42, 99328
    s_mov_b32 m0, s39
    s_nop 0
    buffer_load_dwordx4 v11, s[16:19], s38 offen lds
    s_add_u32 s38, s37, 59392
    s_add_u32 s39, s42, 100352
    s_mov_b32 m0, s39
    s_nop 0
    buffer_load_dwordx4 v11, s[16:19], s38 offen lds
    s_add_u32 s38, s37, 60416
    s_add_u32 s39, s42, 101376
    s_mov_b32 m0, s39
    s_nop 0
    buffer_load_dwordx4 v11, s[16:19], s38 offen lds
    ds_read_b64_tr_b16 v[96:97], v9 offset:0
    ds_read_b64_tr_b16 v[98:99], v9 offset:1024
    ds_read_b128 v[16:19], v12 offset:0
    ds_read_b64_tr_b16 v[100:101], v9 offset:2048
    ds_read_b64_tr_b16 v[102:103], v9 offset:3072
    ds_read_b128 v[20:23], v12 offset:1024
    ds_read_b64_tr_b16 v[104:105], v9 offset:4096
    ds_read_b64_tr_b16 v[106:107], v9 offset:5120
    ds_read_b128 v[24:27], v12 offset:2048
    ds_read_b64_tr_b16 v[108:109], v9 offset:6144
    ds_read_b64_tr_b16 v[110:111], v9 offset:7168
    ds_read_b128 v[28:31], v12 offset:3072
    ds_read_b64_tr_b16 v[112:113], v9 offset:8192
    ds_read_b64_tr_b16 v[114:115], v9 offset:9216
    ds_read_b128 v[32:35], v12 offset:4096
    ds_read_b64_tr_b16 v[116:117], v9 offset:10240
    ds_read_b64_tr_b16 v[118:119], v9 offset:11264
    ds_read_b128 v[36:39], v12 offset:5120
    ds_read_b64_tr_b16 v[120:121], v9 offset:12288
    ds_read_b64_tr_b16 v[122:123], v9 offset:13312
    ds_read_b128 v[40:43], v12 offset:6144
    ds_read_b64_tr_b16 v[124:125], v9 offset:14336
    ds_read_b64_tr_b16 v[126:127], v9 offset:15360
    ds_read_b128 v[44:47], v12 offset:7168
    s_waitcnt lgkmcnt(15)
    v_mfma_f32_32x32x16_bf16 v[80:95], v[96:99], v[16:19], v[80:95]
    s_waitcnt lgkmcnt(15)
    v_mfma_f32_32x32x16_bf16 v[80:95], v[100:103], v[20:23], v[80:95]
    s_waitcnt lgkmcnt(15)
    v_mfma_f32_32x32x16_bf16 v[80:95], v[104:107], v[24:27], v[80:95]
    s_waitcnt lgkmcnt(12)
    v_mfma_f32_32x32x16_bf16 v[80:95], v[108:111], v[28:31], v[80:95]
    s_waitcnt lgkmcnt(9)
    v_mfma_f32_32x32x16_bf16 v[80:95], v[112:115], v[32:35], v[80:95]
    s_waitcnt lgkmcnt(6)
    v_mfma_f32_32x32x16_bf16 v[80:95], v[116:119], v[36:39], v[80:95]
    s_waitcnt lgkmcnt(3)
    v_mfma_f32_32x32x16_bf16 v[80:95], v[120:123], v[40:43], v[80:95]
    s_waitcnt lgkmcnt(0)
    v_mfma_f32_32x32x16_bf16 v[80:95], v[124:127], v[44:47], v[80:95]
    s_waitcnt vmcnt(16)
    s_barrier
    s_add_u32 s38, s44, 1048576
    s_add_u32 s39, s43, 0
    s_mov_b32 m0, s39
    s_nop 0
    buffer_load_dwordx4 v4, s[12:15], s38 offen lds
    s_add_u32 s38, s44, 1056768
    s_add_u32 s39, s43, 1024
    s_mov_b32 m0, s39
    s_nop 0
    buffer_load_dwordx4 v4, s[12:15], s38 offen lds
    s_add_u32 s38, s44, 1064960
    s_add_u32 s39, s43, 2048
    s_mov_b32 m0, s39
    s_nop 0
    buffer_load_dwordx4 v4, s[12:15], s38 offen lds
    s_add_u32 s38, s44, 1073152
    s_add_u32 s39, s43, 3072
    s_mov_b32 m0, s39
    s_nop 0
    buffer_load_dwordx4 v4, s[12:15], s38 offen lds
    s_add_u32 s38, s37, 65536
    s_add_u32 s39, s42, 0
    s_mov_b32 m0, s39
    s_nop 0
    buffer_load_dwordx4 v11, s[16:19], s38 offen lds
    s_add_u32 s38, s37, 66560
    s_add_u32 s39, s42, 1024
    s_mov_b32 m0, s39
    s_nop 0
    buffer_load_dwordx4 v11, s[16:19], s38 offen lds
    s_add_u32 s38, s37, 67584
    s_add_u32 s39, s42, 2048
    s_mov_b32 m0, s39
    s_nop 0
    buffer_load_dwordx4 v11, s[16:19], s38 offen lds
    s_add_u32 s38, s37, 68608
    s_add_u32 s39, s42, 3072
    s_mov_b32 m0, s39
    s_nop 0
    buffer_load_dwordx4 v11, s[16:19], s38 offen lds
    ds_read_b64_tr_b16 v[96:97], v9 offset:32768
    ds_read_b64_tr_b16 v[98:99], v9 offset:33792
    ds_read_b128 v[16:19], v12 offset:32768
    ds_read_b64_tr_b16 v[100:101], v9 offset:34816
    ds_read_b64_tr_b16 v[102:103], v9 offset:35840
    ds_read_b128 v[20:23], v12 offset:33792
    ds_read_b64_tr_b16 v[104:105], v9 offset:36864
    ds_read_b64_tr_b16 v[106:107], v9 offset:37888
    ds_read_b128 v[24:27], v12 offset:34816
    ds_read_b64_tr_b16 v[108:109], v9 offset:38912
    ds_read_b64_tr_b16 v[110:111], v9 offset:39936
    ds_read_b128 v[28:31], v12 offset:35840
    ds_read_b64_tr_b16 v[112:113], v9 offset:40960
    ds_read_b64_tr_b16 v[114:115], v9 offset:41984
    ds_read_b128 v[32:35], v12 offset:36864
    ds_read_b64_tr_b16 v[116:117], v9 offset:43008
    ds_read_b64_tr_b16 v[118:119], v9 offset:44032
    ds_read_b128 v[36:39], v12 offset:37888
    ds_read_b64_tr_b16 v[120:121], v9 offset:45056
    ds_read_b64_tr_b16 v[122:123], v9 offset:46080
    ds_read_b128 v[40:43], v12 offset:38912
    ds_read_b64_tr_b16 v[124:125], v9 offset:47104
    ds_read_b64_tr_b16 v[126:127], v9 offset:48128
    ds_read_b128 v[44:47], v12 offset:39936
    s_waitcnt lgkmcnt(15)
    v_mfma_f32_32x32x16_bf16 v[80:95], v[96:99], v[16:19], v[80:95]
    s_waitcnt lgkmcnt(15)
    v_mfma_f32_32x32x16_bf16 v[80:95], v[100:103], v[20:23], v[80:95]
    s_waitcnt lgkmcnt(15)
    v_mfma_f32_32x32x16_bf16 v[80:95], v[104:107], v[24:27], v[80:95]
    s_waitcnt lgkmcnt(12)
    v_mfma_f32_32x32x16_bf16 v[80:95], v[108:111], v[28:31], v[80:95]
    s_waitcnt lgkmcnt(9)
    v_mfma_f32_32x32x16_bf16 v[80:95], v[112:115], v[32:35], v[80:95]
    s_waitcnt lgkmcnt(6)
    v_mfma_f32_32x32x16_bf16 v[80:95], v[116:119], v[36:39], v[80:95]
    s_waitcnt lgkmcnt(3)
    v_mfma_f32_32x32x16_bf16 v[80:95], v[120:123], v[40:43], v[80:95]
    s_waitcnt lgkmcnt(0)
    v_mfma_f32_32x32x16_bf16 v[80:95], v[124:127], v[44:47], v[80:95]
    s_waitcnt vmcnt(16)
    s_barrier
    s_add_u32 s38, s44, 1179648
    s_add_u32 s39, s43, 32768
    s_mov_b32 m0, s39
    s_nop 0
    buffer_load_dwordx4 v4, s[12:15], s38 offen lds
    s_add_u32 s38, s44, 1187840
    s_add_u32 s39, s43, 33792
    s_mov_b32 m0, s39
    s_nop 0
    buffer_load_dwordx4 v4, s[12:15], s38 offen lds
    s_add_u32 s38, s44, 1196032
    s_add_u32 s39, s43, 34816
    s_mov_b32 m0, s39
    s_nop 0
    buffer_load_dwordx4 v4, s[12:15], s38 offen lds
    s_add_u32 s38, s44, 1204224
    s_add_u32 s39, s43, 35840
    s_mov_b32 m0, s39
    s_nop 0
    buffer_load_dwordx4 v4, s[12:15], s38 offen lds
    s_add_u32 s38, s37, 73728
    s_add_u32 s39, s42, 32768
    s_mov_b32 m0, s39
    s_nop 0
    buffer_load_dwordx4 v11, s[16:19], s38 offen lds
    s_add_u32 s38, s37, 74752
    s_add_u32 s39, s42, 33792
    s_mov_b32 m0, s39
    s_nop 0
    buffer_load_dwordx4 v11, s[16:19], s38 offen lds
    s_add_u32 s38, s37, 75776
    s_add_u32 s39, s42, 34816
    s_mov_b32 m0, s39
    s_nop 0
    buffer_load_dwordx4 v11, s[16:19], s38 offen lds
    s_add_u32 s38, s37, 76800
    s_add_u32 s39, s42, 35840
    s_mov_b32 m0, s39
    s_nop 0
    buffer_load_dwordx4 v11, s[16:19], s38 offen lds
    ds_read_b64_tr_b16 v[96:97], v10 offset:0
    ds_read_b64_tr_b16 v[98:99], v10 offset:1024
    ds_read_b128 v[16:19], v13 offset:0
    ds_read_b64_tr_b16 v[100:101], v10 offset:2048
    ds_read_b64_tr_b16 v[102:103], v10 offset:3072
    ds_read_b128 v[20:23], v13 offset:1024
    ds_read_b64_tr_b16 v[104:105], v10 offset:4096
    ds_read_b64_tr_b16 v[106:107], v10 offset:5120
    ds_read_b128 v[24:27], v13 offset:2048
    ds_read_b64_tr_b16 v[108:109], v10 offset:6144
    ds_read_b64_tr_b16 v[110:111], v10 offset:7168
    ds_read_b128 v[28:31], v13 offset:3072
    ds_read_b64_tr_b16 v[112:113], v10 offset:8192
    ds_read_b64_tr_b16 v[114:115], v10 offset:9216
    ds_read_b128 v[32:35], v13 offset:4096
    ds_read_b64_tr_b16 v[116:117], v10 offset:10240
    ds_read_b64_tr_b16 v[118:119], v10 offset:11264
    ds_read_b128 v[36:39], v13 offset:5120
    ds_read_b64_tr_b16 v[120:121], v10 offset:12288
    ds_read_b64_tr_b16 v[122:123], v10 offset:13312
    ds_read_b128 v[40:43], v13 offset:6144
    ds_read_b64_tr_b16 v[124:125], v10 offset:14336
    ds_read_b64_tr_b16 v[126:127], v10 offset:15360
    ds_read_b128 v[44:47], v13 offset:7168
    s_waitcnt lgkmcnt(15)
    v_mfma_f32_32x32x16_bf16 v[80:95], v[96:99], v[16:19], v[80:95]
    s_waitcnt lgkmcnt(15)
    v_mfma_f32_32x32x16_bf16 v[80:95], v[100:103], v[20:23], v[80:95]
    s_waitcnt lgkmcnt(15)
    v_mfma_f32_32x32x16_bf16 v[80:95], v[104:107], v[24:27], v[80:95]
    s_waitcnt lgkmcnt(12)
    v_mfma_f32_32x32x16_bf16 v[80:95], v[108:111], v[28:31], v[80:95]
    s_waitcnt lgkmcnt(9)
    v_mfma_f32_32x32x16_bf16 v[80:95], v[112:115], v[32:35], v[80:95]
    s_waitcnt lgkmcnt(6)
    v_mfma_f32_32x32x16_bf16 v[80:95], v[116:119], v[36:39], v[80:95]
    s_waitcnt lgkmcnt(3)
    v_mfma_f32_32x32x16_bf16 v[80:95], v[120:123], v[40:43], v[80:95]
    s_waitcnt lgkmcnt(0)
    v_mfma_f32_32x32x16_bf16 v[80:95], v[124:127], v[44:47], v[80:95]
    s_waitcnt vmcnt(16)
    s_barrier
    s_add_u32 s38, s44, 1310720
    s_add_u32 s39, s43, 65536
    s_mov_b32 m0, s39
    s_nop 0
    buffer_load_dwordx4 v4, s[12:15], s38 offen lds
    s_add_u32 s38, s44, 1318912
    s_add_u32 s39, s43, 66560
    s_mov_b32 m0, s39
    s_nop 0
    buffer_load_dwordx4 v4, s[12:15], s38 offen lds
    s_add_u32 s38, s44, 1327104
    s_add_u32 s39, s43, 67584
    s_mov_b32 m0, s39
    s_nop 0
    buffer_load_dwordx4 v4, s[12:15], s38 offen lds
    s_add_u32 s38, s44, 1335296
    s_add_u32 s39, s43, 68608
    s_mov_b32 m0, s39
    s_nop 0
    buffer_load_dwordx4 v4, s[12:15], s38 offen lds
    s_add_u32 s38, s37, 81920
    s_add_u32 s39, s42, 65536
    s_mov_b32 m0, s39
    s_nop 0
    buffer_load_dwordx4 v11, s[16:19], s38 offen lds
    s_add_u32 s38, s37, 82944
    s_add_u32 s39, s42, 66560
    s_mov_b32 m0, s39
    s_nop 0
    buffer_load_dwordx4 v11, s[16:19], s38 offen lds
    s_cmp_eq_u32 s6, 1
    s_cbranch_scc1 K3_SK2
    s_add_u32 s38, s37, 83968
    s_add_u32 s39, s42, 67584
    s_mov_b32 m0, s39
    s_nop 0
    buffer_load_dwordx4 v11, s[16:19], s38 offen lds
K3_SK2:
    s_cmp_eq_u32 s6, 1
    s_cbranch_scc1 K3_SK3
    s_add_u32 s38, s37, 84992
    s_add_u32 s39, s42, 68608
    s_mov_b32 m0, s39
    s_nop 0
    buffer_load_dwordx4 v11, s[16:19], s38 offen lds
K3_SK3:
    ds_read_b64_tr_b16 v[96:97], v10 offset:32768
    ds_read_b64_tr_b16 v[98:99], v10 offset:33792
    ds_read_b128 v[16:19], v13 offset:32768
    ds_read_b64_tr_b16 v[100:101], v10 offset:34816
    ds_read_b64_tr_b16 v[102:103], v10 offset:35840
    ds_read_b128 v[20:23], v13 offset:33792
    ds_read_b64_tr_b16 v[104:105], v10 offset:36864
    ds_read_b64_tr_b16 v[106:107], v10 offset:37888
    ds_read_b128 v[24:27], v13 offset:34816
    ds_read_b64_tr_b16 v[108:109], v10 offset:38912
    ds_read_b64_tr_b16 v[110:111], v10 offset:39936
    ds_read_b128 v[28:31], v13 offset:35840
    ds_read_b64_tr_b16 v[112:113], v10 offset:40960
    ds_read_b64_tr_b16 v[114:115], v10 offset:41984
    ds_read_b128 v[32:35], v13 offset:36864
    ds_read_b64_tr_b16 v[116:117], v10 offset:43008
    ds_read_b64_tr_b16 v[118:119], v10 offset:44032
    ds_read_b128 v[36:39], v13 offset:37888
    ds_read_b64_tr_b16 v[120:121], v10 offset:45056
    ds_read_b64_tr_b16 v[122:123], v10 offset:46080
    ds_read_b128 v[40:43], v13 offset:38912
    ds_read_b64_tr_b16 v[124:125], v10 offset:47104
    ds_read_b64_tr_b16 v[126:127], v10 offset:48128
    ds_read_b128 v[44:47], v13 offset:39936
    s_waitcnt lgkmcnt(15)
    v_mfma_f32_32x32x16_bf16 v[80:95], v[96:99], v[16:19], v[80:95]
    s_waitcnt lgkmcnt(15)
    v_mfma_f32_32x32x16_bf16 v[80:95], v[100:103], v[20:23], v[80:95]
    s_waitcnt lgkmcnt(15)
    v_mfma_f32_32x32x16_bf16 v[80:95], v[104:107], v[24:27], v[80:95]
    s_waitcnt lgkmcnt(12)
    v_mfma_f32_32x32x16_bf16 v[80:95], v[108:111], v[28:31], v[80:95]
    s_waitcnt lgkmcnt(9)
    v_mfma_f32_32x32x16_bf16 v[80:95], v[112:115], v[32:35], v[80:95]
    s_waitcnt lgkmcnt(6)
    v_mfma_f32_32x32x16_bf16 v[80:95], v[116:119], v[36:39], v[80:95]
    s_waitcnt lgkmcnt(3)
    v_mfma_f32_32x32x16_bf16 v[80:95], v[120:123], v[40:43], v[80:95]
    s_waitcnt lgkmcnt(0)
    v_mfma_f32_32x32x16_bf16 v[80:95], v[124:127], v[44:47], v[80:95]
    s_waitcnt vmcnt(14)
    s_barrier
    ds_read_b64_tr_b16 v[96:97], v9 offset:0
    ds_read_b64_tr_b16 v[98:99], v9 offset:1024
    ds_read_b128 v[16:19], v12 offset:0
    ds_read_b64_tr_b16 v[100:101], v9 offset:2048
    ds_read_b64_tr_b16 v[102:103], v9 offset:3072
    ds_read_b128 v[20:23], v12 offset:1024
    ds_read_b64_tr_b16 v[104:105], v9 offset:4096
    ds_read_b64_tr_b16 v[106:107], v9 offset:5120
    ds_read_b128 v[24:27], v12 offset:2048
    ds_read_b64_tr_b16 v[108:109], v9 offset:6144
    ds_read_b64_tr_b16 v[110:111], v9 offset:7168
    ds_read_b128 v[28:31], v12 offset:3072
    ds_read_b64_tr_b16 v[112:113], v9 offset:8192
    ds_read_b64_tr_b16 v[114:115], v9 offset:9216
    ds_read_b128 v[32:35], v12 offset:4096
    ds_read_b64_tr_b16 v[116:117], v9 offset:10240
    ds_read_b64_tr_b16 v[118:119], v9 offset:11264
    ds_read_b128 v[36:39], v12 offset:5120
    ds_read_b64_tr_b16 v[120:121], v9 offset:12288
    ds_read_b64_tr_b16 v[122:123], v9 offset:13312
    ds_read_b128 v[40:43], v12 offset:6144
    ds_read_b64_tr_b16 v[124:125], v9 offset:14336
    ds_read_b64_tr_b16 v[126:127], v9 offset:15360
    ds_read_b128 v[44:47], v12 offset:7168
    s_waitcnt lgkmcnt(15)
    v_mfma_f32_32x32x16_bf16 v[80:95], v[96:99], v[16:19], v[80:95]
    s_waitcnt lgkmcnt(15)
    v_mfma_f32_32x32x16_bf16 v[80:95], v[100:103], v[20:23], v[80:95]
    s_waitcnt lgkmcnt(15)
    v_mfma_f32_32x32x16_bf16 v[80:95], v[104:107], v[24:27], v[80:95]
    s_waitcnt lgkmcnt(12)
    v_mfma_f32_32x32x16_bf16 v[80:95], v[108:111], v[28:31], v[80:95]
    s_waitcnt lgkmcnt(9)
    v_mfma_f32_32x32x16_bf16 v[80:95], v[112:115], v[32:35], v[80:95]
    s_waitcnt lgkmcnt(6)
    v_mfma_f32_32x32x16_bf16 v[80:95], v[116:119], v[36:39], v[80:95]
    s_waitcnt lgkmcnt(3)
    v_mfma_f32_32x32x16_bf16 v[80:95], v[120:123], v[40:43], v[80:95]
    s_waitcnt lgkmcnt(0)
    v_mfma_f32_32x32x16_bf16 v[80:95], v[124:127], v[44:47], v[80:95]
    s_waitcnt vmcnt(0)
    s_barrier
    ds_read_b64_tr_b16 v[96:97], v9 offset:32768
    ds_read_b64_tr_b16 v[98:99], v9 offset:33792
    ds_read_b128 v[16:19], v12 offset:32768
    ds_read_b64_tr_b16 v[100:101], v9 offset:34816
    ds_read_b64_tr_b16 v[102:103], v9 offset:35840
    ds_read_b128 v[20:23], v12 offset:33792
    ds_read_b64_tr_b16 v[104:105], v9 offset:36864
    ds_read_b64_tr_b16 v[106:107], v9 offset:37888
    ds_read_b128 v[24:27], v12 offset:34816
    ds_read_b64_tr_b16 v[108:109], v9 offset:38912
    ds_read_b64_tr_b16 v[110:111], v9 offset:39936
    ds_read_b128 v[28:31], v12 offset:35840
    ds_read_b64_tr_b16 v[112:113], v9 offset:40960
    ds_read_b64_tr_b16 v[114:115], v9 offset:41984
    ds_read_b128 v[32:35], v12 offset:36864
    ds_read_b64_tr_b16 v[116:117], v9 offset:43008
    ds_read_b64_tr_b16 v[118:119], v9 offset:44032
    ds_read_b128 v[36:39], v12 offset:37888
    ds_read_b64_tr_b16 v[120:121], v9 offset:45056
    ds_read_b64_tr_b16 v[122:123], v9 offset:46080
    ds_read_b128 v[40:43], v12 offset:38912
    ds_read_b64_tr_b16 v[124:125], v9 offset:47104
    ds_read_b64_tr_b16 v[126:127], v9 offset:48128
    ds_read_b128 v[44:47], v12 offset:39936
    s_waitcnt lgkmcnt(15)
    v_mfma_f32_32x32x16_bf16 v[80:95], v[96:99], v[16:19], v[80:95]
    s_waitcnt lgkmcnt(15)
    v_mfma_f32_32x32x16_bf16 v[80:95], v[100:103], v[20:23], v[80:95]
    s_waitcnt lgkmcnt(15)
    v_mfma_f32_32x32x16_bf16 v[80:95], v[104:107], v[24:27], v[80:95]
    s_waitcnt lgkmcnt(12)
    v_mfma_f32_32x32x16_bf16 v[80:95], v[108:111], v[28:31], v[80:95]
    s_waitcnt lgkmcnt(9)
    v_mfma_f32_32x32x16_bf16 v[80:95], v[112:115], v[32:35], v[80:95]
    s_waitcnt lgkmcnt(6)
    v_mfma_f32_32x32x16_bf16 v[80:95], v[116:119], v[36:39], v[80:95]
    s_waitcnt lgkmcnt(3)
    v_mfma_f32_32x32x16_bf16 v[80:95], v[120:123], v[40:43], v[80:95]
    s_waitcnt lgkmcnt(0)
    v_mfma_f32_32x32x16_bf16 v[80:95], v[124:127], v[44:47], v[80:95]
    s_waitcnt vmcnt(0)
    s_barrier
    ds_read_b64_tr_b16 v[96:97], v10 offset:0
    ds_read_b64_tr_b16 v[98:99], v10 offset:1024
    ds_read_b128 v[16:19], v13 offset:0
    ds_read_b64_tr_b16 v[100:101], v10 offset:2048
    ds_read_b64_tr_b16 v[102:103], v10 offset:3072
    ds_read_b128 v[20:23], v13 offset:1024
    ds_read_b64_tr_b16 v[104:105], v10 offset:4096
    ds_read_b64_tr_b16 v[106:107], v10 offset:5120
    ds_read_b128 v[24:27], v13 offset:2048
    ds_read_b64_tr_b16 v[108:109], v10 offset:6144
    ds_read_b64_tr_b16 v[110:111], v10 offset:7168
    ds_read_b128 v[28:31], v13 offset:3072
    ds_read_b64_tr_b16 v[112:113], v10 offset:8192
    ds_read_b64_tr_b16 v[114:115], v10 offset:9216
    ds_read_b128 v[32:35], v13 offset:4096
    ds_read_b64_tr_b16 v[116:117], v10 offset:10240
    ds_read_b64_tr_b16 v[118:119], v10 offset:11264
    ds_read_b128 v[36:39], v13 offset:5120
    s_waitcnt lgkmcnt(15)
    v_mfma_f32_32x32x16_bf16 v[80:95], v[96:99], v[16:19], v[80:95]
    s_waitcnt lgkmcnt(12)
    v_mfma_f32_32x32x16_bf16 v[80:95], v[100:103], v[20:23], v[80:95]
    s_waitcnt lgkmcnt(9)
    v_mfma_f32_32x32x16_bf16 v[80:95], v[104:107], v[24:27], v[80:95]
    s_waitcnt lgkmcnt(6)
    v_mfma_f32_32x32x16_bf16 v[80:95], v[108:111], v[28:31], v[80:95]
    s_waitcnt lgkmcnt(3)
    v_mfma_f32_32x32x16_bf16 v[80:95], v[112:115], v[32:35], v[80:95]
    s_waitcnt lgkmcnt(0)
    v_mfma_f32_32x32x16_bf16 v[80:95], v[116:119], v[36:39], v[80:95]
    s_lshl_b32 s38, s24, 7
    s_add_u32 s38, s38, 14680064
    v_and_b32 v2, 31, v1
    v_lshlrev_b32 v3, 2, v2
    buffer_load_dword v12, v3, s[16:19], s38 offen
    s_nop 7
    s_nop 7
    s_waitcnt vmcnt(0)
    v_sub_f32 v13, 1.0, v12
    v_cvt_pk_bf16_f32 v13, v13, v13
    v_lshlrev_b32 v13, 16, v13
    s_lshl_b32 s38, s24, 5
    v_add_u32 v2, s38, v2
    v_lshlrev_b32 v2, 10, v2
    v_lshrrev_b32 v3, 5, v1
    v_lshl_add_u32 v2, v3, 3, v2
    s_lshl_b32 s38, s25, 6
    v_add_u32 v2, s38, v2
    v_cvt_pk_bf16_f32 v14, v64, v64
    v_lshlrev_b32 v14, 16, v14
    v_mul_f32 v14, v12, v14
    v_cvt_pk_bf16_f32 v14, v14, v14
    v_lshlrev_b32 v14, 16, v14
    v_cvt_pk_bf16_f32 v15, v80, v80
    v_lshlrev_b32 v15, 16, v15
    v_mul_f32 v15, v13, v15
    v_cvt_pk_bf16_f32 v15, v15, v15
    v_lshlrev_b32 v15, 16, v15
    v_add_f32 v100, v14, v15
    v_cvt_pk_bf16_f32 v14, v65, v65
    v_lshlrev_b32 v14, 16, v14
    v_mul_f32 v14, v12, v14
    v_cvt_pk_bf16_f32 v14, v14, v14
    v_lshlrev_b32 v14, 16, v14
    v_cvt_pk_bf16_f32 v15, v81, v81
    v_lshlrev_b32 v15, 16, v15
    v_mul_f32 v15, v13, v15
    v_cvt_pk_bf16_f32 v15, v15, v15
    v_lshlrev_b32 v15, 16, v15
    v_add_f32 v101, v14, v15
    v_cvt_pk_bf16_f32 v14, v66, v66
    v_lshlrev_b32 v14, 16, v14
    v_mul_f32 v14, v12, v14
    v_cvt_pk_bf16_f32 v14, v14, v14
    v_lshlrev_b32 v14, 16, v14
    v_cvt_pk_bf16_f32 v15, v82, v82
    v_lshlrev_b32 v15, 16, v15
    v_mul_f32 v15, v13, v15
    v_cvt_pk_bf16_f32 v15, v15, v15
    v_lshlrev_b32 v15, 16, v15
    v_add_f32 v102, v14, v15
    v_cvt_pk_bf16_f32 v14, v67, v67
    v_lshlrev_b32 v14, 16, v14
    v_mul_f32 v14, v12, v14
    v_cvt_pk_bf16_f32 v14, v14, v14
    v_lshlrev_b32 v14, 16, v14
    v_cvt_pk_bf16_f32 v15, v83, v83
    v_lshlrev_b32 v15, 16, v15
    v_mul_f32 v15, v13, v15
    v_cvt_pk_bf16_f32 v15, v15, v15
    v_lshlrev_b32 v15, 16, v15
    v_add_f32 v103, v14, v15
    v_cvt_pk_bf16_f32 v104, v100, v101
    v_cvt_pk_bf16_f32 v105, v102, v103
    buffer_store_dwordx2 v[104:105], v2, s[20:23], 0 offen offset:0
    s_nop 1
    v_cvt_pk_bf16_f32 v14, v68, v68
    v_lshlrev_b32 v14, 16, v14
    v_mul_f32 v14, v12, v14
    v_cvt_pk_bf16_f32 v14, v14, v14
    v_lshlrev_b32 v14, 16, v14
    v_cvt_pk_bf16_f32 v15, v84, v84
    v_lshlrev_b32 v15, 16, v15
    v_mul_f32 v15, v13, v15
    v_cvt_pk_bf16_f32 v15, v15, v15
    v_lshlrev_b32 v15, 16, v15
    v_add_f32 v100, v14, v15
    v_cvt_pk_bf16_f32 v14, v69, v69
    v_lshlrev_b32 v14, 16, v14
    v_mul_f32 v14, v12, v14
    v_cvt_pk_bf16_f32 v14, v14, v14
    v_lshlrev_b32 v14, 16, v14
    v_cvt_pk_bf16_f32 v15, v85, v85
    v_lshlrev_b32 v15, 16, v15
    v_mul_f32 v15, v13, v15
    v_cvt_pk_bf16_f32 v15, v15, v15
    v_lshlrev_b32 v15, 16, v15
    v_add_f32 v101, v14, v15
    v_cvt_pk_bf16_f32 v14, v70, v70
    v_lshlrev_b32 v14, 16, v14
    v_mul_f32 v14, v12, v14
    v_cvt_pk_bf16_f32 v14, v14, v14
    v_lshlrev_b32 v14, 16, v14
    v_cvt_pk_bf16_f32 v15, v86, v86
    v_lshlrev_b32 v15, 16, v15
    v_mul_f32 v15, v13, v15
    v_cvt_pk_bf16_f32 v15, v15, v15
    v_lshlrev_b32 v15, 16, v15
    v_add_f32 v102, v14, v15
    v_cvt_pk_bf16_f32 v14, v71, v71
    v_lshlrev_b32 v14, 16, v14
    v_mul_f32 v14, v12, v14
    v_cvt_pk_bf16_f32 v14, v14, v14
    v_lshlrev_b32 v14, 16, v14
    v_cvt_pk_bf16_f32 v15, v87, v87
    v_lshlrev_b32 v15, 16, v15
    v_mul_f32 v15, v13, v15
    v_cvt_pk_bf16_f32 v15, v15, v15
    v_lshlrev_b32 v15, 16, v15
    v_add_f32 v103, v14, v15
    v_cvt_pk_bf16_f32 v104, v100, v101
    v_cvt_pk_bf16_f32 v105, v102, v103
    buffer_store_dwordx2 v[104:105], v2, s[20:23], 0 offen offset:16
    s_nop 1
    v_cvt_pk_bf16_f32 v14, v72, v72
    v_lshlrev_b32 v14, 16, v14
    v_mul_f32 v14, v12, v14
    v_cvt_pk_bf16_f32 v14, v14, v14
    v_lshlrev_b32 v14, 16, v14
    v_cvt_pk_bf16_f32 v15, v88, v88
    v_lshlrev_b32 v15, 16, v15
    v_mul_f32 v15, v13, v15
    v_cvt_pk_bf16_f32 v15, v15, v15
    v_lshlrev_b32 v15, 16, v15
    v_add_f32 v100, v14, v15
    v_cvt_pk_bf16_f32 v14, v73, v73
    v_lshlrev_b32 v14, 16, v14
    v_mul_f32 v14, v12, v14
    v_cvt_pk_bf16_f32 v14, v14, v14
    v_lshlrev_b32 v14, 16, v14
    v_cvt_pk_bf16_f32 v15, v89, v89
    v_lshlrev_b32 v15, 16, v15
    v_mul_f32 v15, v13, v15
    v_cvt_pk_bf16_f32 v15, v15, v15
    v_lshlrev_b32 v15, 16, v15
    v_add_f32 v101, v14, v15
    v_cvt_pk_bf16_f32 v14, v74, v74
    v_lshlrev_b32 v14, 16, v14
    v_mul_f32 v14, v12, v14
    v_cvt_pk_bf16_f32 v14, v14, v14
    v_lshlrev_b32 v14, 16, v14
    v_cvt_pk_bf16_f32 v15, v90, v90
    v_lshlrev_b32 v15, 16, v15
    v_mul_f32 v15, v13, v15
    v_cvt_pk_bf16_f32 v15, v15, v15
    v_lshlrev_b32 v15, 16, v15
    v_add_f32 v102, v14, v15
    v_cvt_pk_bf16_f32 v14, v75, v75
    v_lshlrev_b32 v14, 16, v14
    v_mul_f32 v14, v12, v14
    v_cvt_pk_bf16_f32 v14, v14, v14
    v_lshlrev_b32 v14, 16, v14
    v_cvt_pk_bf16_f32 v15, v91, v91
    v_lshlrev_b32 v15, 16, v15
    v_mul_f32 v15, v13, v15
    v_cvt_pk_bf16_f32 v15, v15, v15
    v_lshlrev_b32 v15, 16, v15
    v_add_f32 v103, v14, v15
    v_cvt_pk_bf16_f32 v104, v100, v101
    v_cvt_pk_bf16_f32 v105, v102, v103
    buffer_store_dwordx2 v[104:105], v2, s[20:23], 0 offen offset:32
    s_nop 1
    v_cvt_pk_bf16_f32 v14, v76, v76
    v_lshlrev_b32 v14, 16, v14
    v_mul_f32 v14, v12, v14
    v_cvt_pk_bf16_f32 v14, v14, v14
    v_lshlrev_b32 v14, 16, v14
    v_cvt_pk_bf16_f32 v15, v92, v92
    v_lshlrev_b32 v15, 16, v15
    v_mul_f32 v15, v13, v15
    v_cvt_pk_bf16_f32 v15, v15, v15
    v_lshlrev_b32 v15, 16, v15
    v_add_f32 v100, v14, v15
    v_cvt_pk_bf16_f32 v14, v77, v77
    v_lshlrev_b32 v14, 16, v14
    v_mul_f32 v14, v12, v14
    v_cvt_pk_bf16_f32 v14, v14, v14
    v_lshlrev_b32 v14, 16, v14
    v_cvt_pk_bf16_f32 v15, v93, v93
    v_lshlrev_b32 v15, 16, v15
    v_mul_f32 v15, v13, v15
    v_cvt_pk_bf16_f32 v15, v15, v15
    v_lshlrev_b32 v15, 16, v15
    v_add_f32 v101, v14, v15
    v_cvt_pk_bf16_f32 v14, v78, v78
    v_lshlrev_b32 v14, 16, v14
    v_mul_f32 v14, v12, v14
    v_cvt_pk_bf16_f32 v14, v14, v14
    v_lshlrev_b32 v14, 16, v14
    v_cvt_pk_bf16_f32 v15, v94, v94
    v_lshlrev_b32 v15, 16, v15
    v_mul_f32 v15, v13, v15
    v_cvt_pk_bf16_f32 v15, v15, v15
    v_lshlrev_b32 v15, 16, v15
    v_add_f32 v102, v14, v15
    v_cvt_pk_bf16_f32 v14, v79, v79
    v_lshlrev_b32 v14, 16, v14
    v_mul_f32 v14, v12, v14
    v_cvt_pk_bf16_f32 v14, v14, v14
    v_lshlrev_b32 v14, 16, v14
    v_cvt_pk_bf16_f32 v15, v95, v95
    v_lshlrev_b32 v15, 16, v15
    v_mul_f32 v15, v13, v15
    v_cvt_pk_bf16_f32 v15, v15, v15
    v_lshlrev_b32 v15, 16, v15
    v_add_f32 v103, v14, v15
    v_cvt_pk_bf16_f32 v104, v100, v101
    v_cvt_pk_bf16_f32 v105, v102, v103
    buffer_store_dwordx2 v[104:105], v2, s[20:23], 0 offen offset:48
    s_nop 1
K3_END:
    s_endpgm
.section .rodata,"a"
.p2align 6
.amdhsa_kernel qkv_kernel
  .amdhsa_next_free_vgpr 256
  .amdhsa_next_free_sgpr 102
  .amdhsa_accum_offset 256
  .amdhsa_group_segment_fixed_size 0
  .amdhsa_kernarg_size 80
  .amdhsa_user_sgpr_count 2
  .amdhsa_user_sgpr_kernarg_segment_ptr 1
  .amdhsa_system_sgpr_workgroup_id_x 1
.end_amdhsa_kernel

.p2align 6
.amdhsa_kernel attn_kernel
  .amdhsa_next_free_vgpr 256
  .amdhsa_next_free_sgpr 102
  .amdhsa_accum_offset 256
  .amdhsa_group_segment_fixed_size 0
  .amdhsa_kernarg_size 80
  .amdhsa_user_sgpr_count 2
  .amdhsa_user_sgpr_kernarg_segment_ptr 1
  .amdhsa_system_sgpr_workgroup_id_x 1
.end_amdhsa_kernel

.p2align 6
.amdhsa_kernel final_kernel
  .amdhsa_next_free_vgpr 256
  .amdhsa_next_free_sgpr 102
  .amdhsa_accum_offset 256
  .amdhsa_group_segment_fixed_size 0
  .amdhsa_kernarg_size 80
  .amdhsa_user_sgpr_count 2
  .amdhsa_user_sgpr_kernarg_segment_ptr 1
  .amdhsa_system_sgpr_workgroup_id_x 1
.end_amdhsa_kernel
```
